```python
import torch

def _softmax(x, axis=-1):
    return torch.softmax(x, dim=axis)

def _gelu(x):
    return torch.nn.functional.gelu(x, approximate='tanh')

def _silu(x):
    return torch.nn.functional.silu(x)

def _sigmoid(x):
    return torch.sigmoid(x)

def _layernorm(x, axis=-1, eps=1e-05):
    m = x.mean(dim=axis, keepdim=True)
    v = x.var(dim=axis, keepdim=True, unbiased=False)
    return (x - m) / torch.sqrt(v + eps)

def _scatter_add(tgt, idx, src, axis=0):
    return tgt.clone().index_add_(axis, idx, src)

def _segment_sum(src, seg, n):
    out = torch.zeros((n,) + src.shape[1:], dtype=src.dtype)
    return out.index_add_(0, seg, src)

def _pad(x, pw):
    flat = tuple((v for pair in reversed(pw) for v in pair))
    return torch.nn.functional.pad(x, flat)
kernel_name = 'parallel_sum__linear_attn_block__mixer_gmlp__prompt'

def setup_inputs():

    _w = lambda a: (lambda t: t.to(torch.bfloat16) if t.is_floating_point() else t)(torch.as_tensor(a))

    def _A_setup():
        B, S, D = (1, 2048, 448)
        return {'x': _w((lambda *s: torch.randn(*s, dtype=torch.bfloat16) * 0.05)(B, S, D)), 'wqkv': _w((lambda *s: torch.randn(*s, dtype=torch.bfloat16) * 1.6)(D, 3 * D)), 'wo': _w((lambda *s: torch.randn(*s, dtype=torch.bfloat16) * 0.2)(D, D))}
    _A_in = _A_setup()

    def _B_setup():
        B, S, D, F = (1, 2048, 448, 1792)
        Fh = F // 2
        return {'x': _w((lambda *s: torch.randn(*s, dtype=torch.bfloat16) * 0.05)(B, S, D)), 'w_in': _w((lambda *s: torch.randn(*s, dtype=torch.bfloat16) * 0.4)(D, 2 * Fh)), 'w_sp': _w(0.01 * (lambda *s: torch.randn(*s, dtype=torch.bfloat16) * 0.4)(S, S)), 'b_sp': _w(1.0 + 0.01 * (lambda *s: torch.randn(*s, dtype=torch.bfloat16) * 0.05)(S)), 'w_out': _w((lambda *s: torch.randn(*s, dtype=torch.bfloat16) * 0.05)(Fh, D))}
    _B_in = _B_setup()
    return {'A_x': _A_in['x'], 'A_wqkv': _A_in['wqkv'], 'A_wo': _A_in['wo'], 'B_x': _B_in['x'], 'B_w_in': _B_in['w_in'], 'B_w_sp': _B_in['w_sp'], 'B_b_sp': _B_in['b_sp'], 'B_w_out': _B_in['w_out']}

def reference(A_x, A_wqkv, A_wo, B_x, B_w_in, B_w_sp, B_b_sp, B_w_out):

    def _A_ref(x, wqkv, wo):
        B, S, D = x.shape
        H = 16
        Dh = D // H
        qkv = (lambda x, *d: x.permute(*d))((x @ wqkv).reshape(B, S, 3, H, Dh), 2, 0, 3, 1, 4)
        q, k, v = (qkv[0], qkv[1], qkv[2])
        phi = lambda t: torch.where(t > 0, t + 1, torch.exp(t)) + 1e-06
        pq, pk = (phi(q), phi(k))
        kv = torch.einsum('bhsd,bhse->bhde', pk, v)
        z = torch.einsum('bhsd->bhd', pk)
        num = torch.einsum('bhqd,bhde->bhqe', pq, kv)
        den = torch.einsum('bhqd,bhd->bhq', pq, z)[..., None] + 1e-06
        o = num / den
        return (lambda x, *d: x.permute(*d))(o, 0, 2, 1, 3).reshape(B, S, D) @ wo

    def _B_ref(x, w_in, w_sp, b_sp, w_out):
        B, S, D = x.shape
        F = w_in.shape[-1]
        Fh = F // 2
        z = _gelu(torch.einsum('bsd,df->bsf', x, w_in))
        z1 = z[..., :Fh].clone()
        z2 = _layernorm(z[..., Fh:], axis=-1)
        g = torch.einsum('ts,bsf->btf', w_sp, z2) + b_sp[None, :, None]
        return torch.einsum('bsf,fd->bsd', z1 * g, w_out)
    x = A_x
    xn = _layernorm(x, axis=-1)
    return x + _A_ref(xn, A_wqkv, A_wo) + _B_ref(xn, B_w_in, B_w_sp, B_b_sp, B_w_out)
```

```asm
; @launch grid=(256,1,1) block=(512,1,1) lds=163840
.amdgcn_target "amdgcn-amd-amdhsa--gfx950"
.text
.globl parallel_sum__linear_attn_block__mixer_gmlp__prompt_kernel
.p2align 8
.type parallel_sum__linear_attn_block__mixer_gmlp__prompt_kernel,@function
parallel_sum__linear_attn_block__mixer_gmlp__prompt_kernel:
  s_cmp_ge_u32 s2, 256
  s_cbranch_scc1 L_EXIT
  s_load_dwordx2 s[4:5], s[0:1], 0
  s_load_dwordx2 s[12:13], s[0:1], 32
  s_load_dwordx2 s[8:9], s[0:1], 8
  s_load_dwordx2 s[16:17], s[0:1], 80
  s_load_dwordx2 s[20:21], s[0:1], 40
  s_load_dwordx2 s[24:25], s[0:1], 48
  s_load_dwordx2 s[28:29], s[0:1], 16
  s_load_dwordx2 s[32:33], s[0:1], 56
  s_load_dwordx2 s[36:37], s[0:1], 64
  v_lshrrev_b32 v1, 6, v0
  v_and_b32 v0, 63, v0
  v_readfirstlane_b32 s40, v1
  s_getreg_b32 s100, hwreg(HW_REG_XCC_ID, 0, 4)
  s_mov_b32 s6, 1835008
  s_mov_b32 s7, 0x20000
  s_mov_b32 s10, 1204224
  s_mov_b32 s11, 0x20000
  s_mov_b32 s14, 1605632
  s_mov_b32 s15, 0x20000
  s_mov_b32 s18, 21495808
  s_mov_b32 s19, 0x20000
  s_mov_b32 s22, 8388608
  s_mov_b32 s23, 0x20000
  s_mov_b32 s26, 4096
  s_mov_b32 s27, 0x20000
  s_mov_b32 s30, 401408
  s_mov_b32 s31, 0x20000
  s_mov_b32 s34, 802816
  s_mov_b32 s35, 0x20000
  s_mov_b32 s38, 1835008
  s_mov_b32 s39, 0x20000
  s_and_b32 s60, s2, 7
  s_lshl_b32 s60, s60, 2
  s_bfe_u32 s61, s2, 0x20003
  s_add_u32 s41, s60, s61
  s_lshr_b32 s42, s2, 5
  s_mov_b32 s70, s41
  s_mov_b32 s71, s42
  s_lshl_b32 s46, s40, 10
  v_lshrrev_b32 v12, 3, v0
  v_and_b32 v13, 7, v0
  v_lshlrev_b32 v5, 4, v0
  v_mul_u32_u24 v4, 896, v12
  v_lshl_add_u32 v4, v13, 4, v4
  s_lshl_b32 s60, s41, 3
  s_add_u32 s60, s60, s40
  s_mul_i32 s60, s60, 7168
  s_and_b32 s44, s40, 3
  s_lshr_b32 s45, s40, 2
  s_lshr_b32 s47, s44, 1
  v_and_b32 v6, 3, v12
  v_lshrrev_b32 v7, 2, v12
  v_lshl_add_u32 v6, v7, 3, v6
  v_and_b32 v7, 6, v12
  v_xor_b32 v7, v7, v13
  v_lshlrev_b32 v7, 4, v7
  v_mul_u32_u24 v1, 3584, v6
  v_add_u32 v1, v1, v7
  v_mul_u32_u24 v2, 2688, v6
  v_add_u32 v2, v2, v7
  s_lshl_b32 s61, s45, 5
  s_lshl_b32 s63, s47, 4
  s_add_u32 s61, s61, s63
  s_and_b32 s63, s40, 1
  s_lshl_b32 s63, s63, 2
  s_add_u32 s61, s61, s63
  s_mul_i32 s48, s61, 3584
  s_lshl_b32 s63, s42, 8
  s_add_u32 s48, s48, s63
  s_mul_i32 s49, s61, 2688
  s_lshl_b32 s63, s42, 7
  s_add_u32 s49, s49, s63
  s_waitcnt lgkmcnt(0)
  s_lshl_b32 s64, s2, 3
  s_add_u32 s64, s64, s40
  s_lshr_b32 s65, s64, 2
  s_min_u32 s65, s65, 447
  s_mul_i32 s65, s65, 3584
  s_and_b32 s62, s64, 3
  s_lshl_b32 s62, s62, 2
  v_min_u32 v46, 3, v0
  v_add_u32 v46, s62, v46
  v_min_u32 v46, 13, v46
  v_lshlrev_b32 v46, 7, v46
  buffer_load_dword v47, v46, s[12:15], s65 offen offset:1792
  s_mul_i32 s65, s64, 640
  s_min_u32 s65, s65, 1203584
  v_min_u32 v46, 4, v0
  v_lshlrev_b32 v46, 7, v46
  buffer_load_dword v47, v46, s[8:11], s65 offen
  s_min_u32 s64, s42, 6
  s_lshl_b32 s64, s64, 7
  s_add_u32 s64, s64, s60
  buffer_load_dwordx4 v[208:211], v4, s[4:7], s64 offen
  buffer_load_dwordx4 v[16:19], v4, s[4:7], s60 offen offset:0
  buffer_load_dwordx4 v[20:23], v4, s[4:7], s60 offen offset:128
  buffer_load_dwordx4 v[24:27], v4, s[4:7], s60 offen offset:256
  buffer_load_dwordx4 v[28:31], v4, s[4:7], s60 offen offset:384
  buffer_load_dwordx4 v[32:35], v4, s[4:7], s60 offen offset:512
  buffer_load_dwordx4 v[36:39], v4, s[4:7], s60 offen offset:640
  buffer_load_dwordx4 v[40:43], v4, s[4:7], s60 offen offset:768
  s_load_dword s43, s[16:17], 262144
  s_cmp_eq_u32 s42, 7
  s_cbranch_scc1 L_ATT
  s_lshl_b32 s52, s41, 1
  s_add_u32 s52, s52, s45
  s_lshl_b32 s53, s42, 2
  s_add_u32 s53, s53, s44
  v_mov_b32 v248, -1
  v_mov_b32 v249, -1
  v_mov_b32 v250, -1
  v_mov_b32 v251, -1
  s_barrier
  s_add_u32 m0, s46, 0
  s_add_u32 s61, s48, 1792
  buffer_load_dwordx4 v1, s[12:15], s61 offen lds
  s_add_u32 m0, s46, 8192
  s_add_u32 s61, s48, 1920
  buffer_load_dwordx4 v1, s[12:15], s61 offen lds
  s_add_u32 m0, s46, 16384
  s_add_u32 s61, s48, 231168
  buffer_load_dwordx4 v1, s[12:15], s61 offen lds
  s_add_u32 m0, s46, 24576
  s_add_u32 s61, s48, 231296
  buffer_load_dwordx4 v1, s[12:15], s61 offen lds
  s_mov_b32 s63, 0x3f803f80
  v_mov_b32 v104, 0
  v_mov_b32 v105, 0
  v_mov_b32 v106, 0
  v_mov_b32 v107, 0
  s_lshl_b32 s64, s45, 5
  s_lshl_b32 s65, s44, 2
  s_add_u32 s64, s64, s65
  v_lshrrev_b32 v6, 5, v0
  v_lshlrev_b32 v6, 4, v6
  v_and_b32 v7, 3, v12
  v_add3_u32 v6, v6, v7, s64
  v_lshlrev_b32 v7, 7, v6
  v_bfe_u32 v6, v6, 1, 3
  v_xor_b32 v6, v6, v13
  v_lshl_add_u32 v7, v6, 4, v7
  v_add_u32 v112, 98304, v7
  v_and_b32 v8, 15, v0
  v_lshrrev_b32 v6, 4, v0
  v_lshrrev_b32 v7, 1, v8
  v_xor_b32 v6, v6, v7
  v_lshlrev_b32 v6, 4, v6
  v_lshl_add_u32 v6, v8, 7, v6
  s_lshl_b32 s64, s45, 12
  s_add_u32 s64, s64, 98304
  v_add_u32 v6, s64, v6
  v_xor_b32 v7, 64, v6
  v_bfe_u32 v9, v0, 2, 3
  v_lshrrev_b32 v10, 5, v0
  v_lshlrev_b32 v10, 11, v10
  v_lshl_add_u32 v10, v9, 7, v10
  v_and_b32 v8, 3, v0
  v_lshl_add_u32 v10, v8, 3, v10
  v_lshrrev_b32 v9, 1, v9
  v_lshlrev_b32 v9, 5, v9
  v_or_b32 v10, v10, v9
  s_and_b32 s64, s44, 1
  s_lshl_b32 s64, s64, 6
  v_xor_b32 v8, s64, v10
  v_xor_b32 v9, 32, v8
  s_lshl_b32 s64, s44, 5
  v_xor_b32 v10, s64, v10
  v_mov_b32 v252, 0xc0135761
  v_mov_b32 v253, 0xc0135761
  v_mov_b32 v254, 0xbdd2d3e8
  v_mov_b32 v255, 0xbdd2d3e8
  s_lshl_b32 s50, s41, 6
  s_lshl_b32 s64, s45, 5
  s_add_u32 s50, s50, s64
  s_lshl_b32 s64, s47, 2
  s_add_u32 s50, s50, s64
  s_and_b32 s64, s40, 1
  s_lshl_b32 s65, s64, 4
  s_add_u32 s50, s50, s65
  s_lshl_b32 s50, s50, 12
  s_lshl_b32 s64, s64, 2
  v_lshrrev_b32 v14, 4, v0
  v_add_u32 v14, s64, v14
  v_xor_b32 v14, v14, v0
  v_and_b32 v14, 7, v14
  v_lshlrev_b32 v14, 4, v14
  v_lshrrev_b32 v3, 5, v0
  v_lshl_add_u32 v14, v3, 15, v14
  v_bfe_u32 v3, v0, 3, 2
  v_lshl_add_u32 v3, v3, 12, v14
  s_lshl_b32 s56, s53, 17
  s_add_u32 s56, s56, 1048576
  s_lshl_b32 s64, s45, 11
  s_add_u32 s56, s56, s64
  s_bfe_u32 s74, s41, 65539
  s_lshl_b32 s64, s74, 11
  s_add_u32 s50, s50, s64
  s_xor_b32 s51, s50, 2097152
  s_lshl_b32 s64, s74, 16
  s_add_u32 s72, s56, s64
  s_lshl_b32 s73, s42, 5
  s_add_u32 s73, s73, s41
  s_lshl_b32 s73, s73, 3
  s_add_u32 s73, s73, s40
  s_lshl_b32 s73, s73, 11
  s_add_u32 s73, s73, 17825792
  s_getpc_b64 s[76:77]
CP_1:
  s_sub_u32 s76, s76, CP_1-parallel_sum__linear_attn_block__mixer_gmlp__prompt_kernel
  s_subb_u32 s77, s77, 0
  s_mov_b32 s78, L_EXIT-parallel_sum__linear_attn_block__mixer_gmlp__prompt_kernel
  s_mov_b32 s79, 0x20000
  s_lshl_b32 s64, s42, 3
  s_add_u32 s64, s64, s40
  s_lshl_b32 s64, s64, 10
  v_and_b32 v13, 15, v0
  v_lshl_add_u32 v13, v13, 6, s64
  v_min_u32 v13, L_EXIT-parallel_sum__linear_attn_block__mixer_gmlp__prompt_kernel-4, v13
  buffer_load_dword v4, v13, s[76:79], 0 offen
  s_waitcnt vmcnt(11)
  v_dot2c_f32_bf16 v104, s63, v16
  v_dot2c_f32_bf16 v106, v16, v16
  v_dot2c_f32_bf16 v105, s63, v17
  v_dot2c_f32_bf16 v107, v17, v17
  v_dot2c_f32_bf16 v104, s63, v18
  v_dot2c_f32_bf16 v106, v18, v18
  v_dot2c_f32_bf16 v105, s63, v19
  v_dot2c_f32_bf16 v107, v19, v19
  v_lshlrev_b32 v48, 16, v16
  v_and_b32 v49, 0xffff0000, v16
  v_lshlrev_b32 v50, 16, v17
  v_and_b32 v51, 0xffff0000, v17
  v_lshlrev_b32 v52, 16, v18
  v_and_b32 v53, 0xffff0000, v18
  v_lshlrev_b32 v54, 16, v19
  v_and_b32 v55, 0xffff0000, v19
  s_waitcnt vmcnt(10)
  v_dot2c_f32_bf16 v104, s63, v20
  v_dot2c_f32_bf16 v106, v20, v20
  v_dot2c_f32_bf16 v105, s63, v21
  v_dot2c_f32_bf16 v107, v21, v21
  v_dot2c_f32_bf16 v104, s63, v22
  v_dot2c_f32_bf16 v106, v22, v22
  v_dot2c_f32_bf16 v105, s63, v23
  v_dot2c_f32_bf16 v107, v23, v23
  v_lshlrev_b32 v56, 16, v20
  v_and_b32 v57, 0xffff0000, v20
  v_lshlrev_b32 v58, 16, v21
  v_and_b32 v59, 0xffff0000, v21
  v_lshlrev_b32 v60, 16, v22
  v_and_b32 v61, 0xffff0000, v22
  v_lshlrev_b32 v62, 16, v23
  v_and_b32 v63, 0xffff0000, v23
  s_waitcnt vmcnt(9)
  v_dot2c_f32_bf16 v104, s63, v24
  v_dot2c_f32_bf16 v106, v24, v24
  v_dot2c_f32_bf16 v105, s63, v25
  v_dot2c_f32_bf16 v107, v25, v25
  v_dot2c_f32_bf16 v104, s63, v26
  v_dot2c_f32_bf16 v106, v26, v26
  v_dot2c_f32_bf16 v105, s63, v27
  v_dot2c_f32_bf16 v107, v27, v27
  v_lshlrev_b32 v64, 16, v24
  v_and_b32 v65, 0xffff0000, v24
  v_lshlrev_b32 v66, 16, v25
  v_and_b32 v67, 0xffff0000, v25
  v_lshlrev_b32 v68, 16, v26
  v_and_b32 v69, 0xffff0000, v26
  v_lshlrev_b32 v70, 16, v27
  v_and_b32 v71, 0xffff0000, v27
  s_add_u32 m0, s46, 32768
  s_add_u32 s61, s48, 460544
  buffer_load_dwordx4 v1, s[12:15], s61 offen lds
  s_waitcnt vmcnt(9)
  v_dot2c_f32_bf16 v104, s63, v28
  v_dot2c_f32_bf16 v106, v28, v28
  v_dot2c_f32_bf16 v105, s63, v29
  v_dot2c_f32_bf16 v107, v29, v29
  v_dot2c_f32_bf16 v104, s63, v30
  v_dot2c_f32_bf16 v106, v30, v30
  v_dot2c_f32_bf16 v105, s63, v31
  v_dot2c_f32_bf16 v107, v31, v31
  v_lshlrev_b32 v72, 16, v28
  v_and_b32 v73, 0xffff0000, v28
  v_lshlrev_b32 v74, 16, v29
  v_and_b32 v75, 0xffff0000, v29
  v_lshlrev_b32 v76, 16, v30
  v_and_b32 v77, 0xffff0000, v30
  v_lshlrev_b32 v78, 16, v31
  v_and_b32 v79, 0xffff0000, v31
  s_add_u32 m0, s46, 40960
  s_add_u32 s61, s48, 460672
  buffer_load_dwordx4 v1, s[12:15], s61 offen lds
  s_waitcnt vmcnt(9)
  v_dot2c_f32_bf16 v104, s63, v32
  v_dot2c_f32_bf16 v106, v32, v32
  v_dot2c_f32_bf16 v105, s63, v33
  v_dot2c_f32_bf16 v107, v33, v33
  v_dot2c_f32_bf16 v104, s63, v34
  v_dot2c_f32_bf16 v106, v34, v34
  v_dot2c_f32_bf16 v105, s63, v35
  v_dot2c_f32_bf16 v107, v35, v35
  v_lshlrev_b32 v80, 16, v32
  v_and_b32 v81, 0xffff0000, v32
  v_lshlrev_b32 v82, 16, v33
  v_and_b32 v83, 0xffff0000, v33
  v_lshlrev_b32 v84, 16, v34
  v_and_b32 v85, 0xffff0000, v34
  v_lshlrev_b32 v86, 16, v35
  v_and_b32 v87, 0xffff0000, v35
  s_add_u32 m0, s46, 49152
  s_add_u32 s61, s48, 689920
  buffer_load_dwordx4 v1, s[12:15], s61 offen lds
  s_waitcnt vmcnt(9)
  v_dot2c_f32_bf16 v104, s63, v36
  v_dot2c_f32_bf16 v106, v36, v36
  v_dot2c_f32_bf16 v105, s63, v37
  v_dot2c_f32_bf16 v107, v37, v37
  v_dot2c_f32_bf16 v104, s63, v38
  v_dot2c_f32_bf16 v106, v38, v38
  v_dot2c_f32_bf16 v105, s63, v39
  v_dot2c_f32_bf16 v107, v39, v39
  v_lshlrev_b32 v88, 16, v36
  v_and_b32 v89, 0xffff0000, v36
  v_lshlrev_b32 v90, 16, v37
  v_and_b32 v91, 0xffff0000, v37
  v_lshlrev_b32 v92, 16, v38
  v_and_b32 v93, 0xffff0000, v38
  v_lshlrev_b32 v94, 16, v39
  v_and_b32 v95, 0xffff0000, v39
  s_add_u32 m0, s46, 57344
  s_add_u32 s61, s48, 690048
  buffer_load_dwordx4 v1, s[12:15], s61 offen lds
  s_waitcnt vmcnt(9)
  v_dot2c_f32_bf16 v104, s63, v40
  v_dot2c_f32_bf16 v106, v40, v40
  v_dot2c_f32_bf16 v105, s63, v41
  v_dot2c_f32_bf16 v107, v41, v41
  v_dot2c_f32_bf16 v104, s63, v42
  v_dot2c_f32_bf16 v106, v42, v42
  v_dot2c_f32_bf16 v105, s63, v43
  v_dot2c_f32_bf16 v107, v43, v43
  s_add_u32 m0, s46, 65536
  s_add_u32 s61, s48, 919296
  buffer_load_dwordx4 v1, s[12:15], s61 offen lds
  v_lshlrev_b32 v96, 16, v40
  v_and_b32 v97, 0xffff0000, v40
  v_add_f32 v104, v104, v105
  v_add_f32 v106, v106, v107
  v_lshlrev_b32 v98, 16, v41
  v_add_f32_dpp v104, v104, v104 quad_perm:[1,0,3,2] row_mask:0xf bank_mask:0xf
  v_add_f32_dpp v106, v106, v106 quad_perm:[1,0,3,2] row_mask:0xf bank_mask:0xf
  v_and_b32 v99, 0xffff0000, v41
  v_add_f32_dpp v104, v104, v104 quad_perm:[2,3,0,1] row_mask:0xf bank_mask:0xf
  v_add_f32_dpp v106, v106, v106 quad_perm:[2,3,0,1] row_mask:0xf bank_mask:0xf
  v_lshlrev_b32 v100, 16, v42
  v_add_f32_dpp v104, v104, v104 row_half_mirror row_mask:0xf bank_mask:0xf
  v_add_f32_dpp v106, v106, v106 row_half_mirror row_mask:0xf bank_mask:0xf
  v_mul_f32 v104, 0x3b124925, v104
  v_mul_f32 v106, 0x3b124925, v106
  v_fma_f32 v106, -v104, v104, v106
  v_max_f32 v106, 0, v106
  v_add_f32 v106, 0x3727c5ac, v106
  v_rsq_f32 v108, v106
  v_and_b32 v101, 0xffff0000, v42
  v_lshlrev_b32 v102, 16, v43
  v_and_b32 v103, 0xffff0000, v43
  v_mul_f32 v110, -v104, v108
  v_mov_b32 v109, v108
  v_mov_b32 v111, v110
  v_pk_fma_f32 v[48:49], v[48:49], v[108:109], v[110:111]
  v_pk_fma_f32 v[50:51], v[50:51], v[108:109], v[110:111]
  v_pk_fma_f32 v[52:53], v[52:53], v[108:109], v[110:111]
  v_pk_fma_f32 v[54:55], v[54:55], v[108:109], v[110:111]
  v_cvt_pk_bf16_f32 v16, v48, v49
  v_cvt_pk_bf16_f32 v17, v50, v51
  v_cvt_pk_bf16_f32 v18, v52, v53
  v_cvt_pk_bf16_f32 v19, v54, v55
  ds_write_b128 v112, v[16:19] offset:0
  s_add_u32 m0, s46, 73728
  s_add_u32 s61, s48, 919424
  buffer_load_dwordx4 v1, s[12:15], s61 offen lds
  v_pk_fma_f32 v[56:57], v[56:57], v[108:109], v[110:111]
  v_pk_fma_f32 v[58:59], v[58:59], v[108:109], v[110:111]
  v_pk_fma_f32 v[60:61], v[60:61], v[108:109], v[110:111]
  v_pk_fma_f32 v[62:63], v[62:63], v[108:109], v[110:111]
  v_cvt_pk_bf16_f32 v20, v56, v57
  v_cvt_pk_bf16_f32 v21, v58, v59
  v_cvt_pk_bf16_f32 v22, v60, v61
  v_cvt_pk_bf16_f32 v23, v62, v63
  ds_write_b128 v112, v[20:23] offset:8192
  s_add_u32 m0, s46, 81920
  s_add_u32 s61, s48, 1148672
  buffer_load_dwordx4 v1, s[12:15], s61 offen lds
  v_pk_fma_f32 v[64:65], v[64:65], v[108:109], v[110:111]
  v_pk_fma_f32 v[66:67], v[66:67], v[108:109], v[110:111]
  v_pk_fma_f32 v[68:69], v[68:69], v[108:109], v[110:111]
  v_pk_fma_f32 v[70:71], v[70:71], v[108:109], v[110:111]
  v_cvt_pk_bf16_f32 v24, v64, v65
  v_cvt_pk_bf16_f32 v25, v66, v67
  v_cvt_pk_bf16_f32 v26, v68, v69
  v_cvt_pk_bf16_f32 v27, v70, v71
  ds_write_b128 v112, v[24:27] offset:16384
  s_add_u32 m0, s46, 90112
  s_add_u32 s61, s48, 1148800
  buffer_load_dwordx4 v1, s[12:15], s61 offen lds
  v_pk_fma_f32 v[72:73], v[72:73], v[108:109], v[110:111]
  v_pk_fma_f32 v[74:75], v[74:75], v[108:109], v[110:111]
  v_pk_fma_f32 v[76:77], v[76:77], v[108:109], v[110:111]
  v_pk_fma_f32 v[78:79], v[78:79], v[108:109], v[110:111]
  v_cvt_pk_bf16_f32 v28, v72, v73
  v_cvt_pk_bf16_f32 v29, v74, v75
  v_cvt_pk_bf16_f32 v30, v76, v77
  v_cvt_pk_bf16_f32 v31, v78, v79
  ds_write_b128 v112, v[28:31] offset:24576
  v_pk_fma_f32 v[80:81], v[80:81], v[108:109], v[110:111]
  v_pk_fma_f32 v[82:83], v[82:83], v[108:109], v[110:111]
  v_pk_fma_f32 v[84:85], v[84:85], v[108:109], v[110:111]
  v_pk_fma_f32 v[86:87], v[86:87], v[108:109], v[110:111]
  v_cvt_pk_bf16_f32 v32, v80, v81
  v_cvt_pk_bf16_f32 v33, v82, v83
  v_cvt_pk_bf16_f32 v34, v84, v85
  v_cvt_pk_bf16_f32 v35, v86, v87
  ds_write_b128 v112, v[32:35] offset:32768
  v_pk_fma_f32 v[88:89], v[88:89], v[108:109], v[110:111]
  v_pk_fma_f32 v[90:91], v[90:91], v[108:109], v[110:111]
  v_pk_fma_f32 v[92:93], v[92:93], v[108:109], v[110:111]
  v_pk_fma_f32 v[94:95], v[94:95], v[108:109], v[110:111]
  v_cvt_pk_bf16_f32 v36, v88, v89
  v_cvt_pk_bf16_f32 v37, v90, v91
  v_cvt_pk_bf16_f32 v38, v92, v93
  v_cvt_pk_bf16_f32 v39, v94, v95
  ds_write_b128 v112, v[36:39] offset:40960
  v_pk_fma_f32 v[96:97], v[96:97], v[108:109], v[110:111]
  v_pk_fma_f32 v[98:99], v[98:99], v[108:109], v[110:111]
  v_pk_fma_f32 v[100:101], v[100:101], v[108:109], v[110:111]
  v_pk_fma_f32 v[102:103], v[102:103], v[108:109], v[110:111]
  v_cvt_pk_bf16_f32 v40, v96, v97
  v_cvt_pk_bf16_f32 v41, v98, v99
  v_cvt_pk_bf16_f32 v42, v100, v101
  v_cvt_pk_bf16_f32 v43, v102, v103
  ds_write_b128 v112, v[40:43] offset:49152
  s_lshl_b32 s64, s2, 3
  s_add_u32 s64, s64, s40
  s_lshr_b32 s65, s64, 2
  s_min_u32 s65, s65, 447
  s_mul_i32 s65, s65, 3584
  s_and_b32 s62, s64, 3
  s_lshl_b32 s62, s62, 2
  v_min_u32 v13, 3, v0
  v_add_u32 v13, s62, v13
  v_min_u32 v13, 13, v13
  v_lshlrev_b32 v13, 7, v13
  buffer_load_dword v4, v13, s[12:15], s65 offen offset:0
  s_lshl_b32 s64, s2, 3
  s_add_u32 s64, s64, s40
  s_mul_i32 s62, s64, 392
  s_mul_i32 s65, s64, 196
  v_lshlrev_b32 v13, 6, v0
  v_min_u32 v13, 384, v13
  buffer_load_dword v4, v13, s[32:35], s62 offen
  v_min_u32 v13, 192, v13
  buffer_load_dword v4, v13, s[28:31], s65 offen
  s_xor_b32 s62, s73, 131072
  buffer_store_dwordx4 v[248:251], v5, s[16:19], s62 offen offset:0 sc1
  s_xor_b32 s62, s73, 131072
  buffer_store_dwordx4 v[248:251], v5, s[16:19], s62 offen offset:1024 sc1
  s_waitcnt vmcnt(14) lgkmcnt(0)
  s_add_u32 s43, s43, 2654435769
  s_xor_b32 s100, s100, s43
  s_barrier
  s_mul_i32 s64, s47, 8192
  s_add_u32 s64, s64, 0
  v_add_u32 v11, s64, v8
  v_add_u32 v12, s64, v9
  ds_read_b128 v[16:19], v6 offset:0
  ds_read_b128 v[20:23], v6 offset:2048
  ds_read_b128 v[24:27], v7 offset:0
  ds_read_b128 v[28:31], v7 offset:2048
  ds_read_b64_tr_b16 v[128:129], v11 offset:0
  ds_read_b64_tr_b16 v[130:131], v11 offset:1024
  ds_read_b64_tr_b16 v[132:133], v12 offset:0
  ds_read_b64_tr_b16 v[134:135], v12 offset:1024
  ds_read_b64_tr_b16 v[140:141], v11 offset:4096
  ds_read_b64_tr_b16 v[142:143], v11 offset:5120
  ds_read_b64_tr_b16 v[144:145], v12 offset:4096
  ds_read_b64_tr_b16 v[146:147], v12 offset:5120
  s_mul_i32 s64, s47, 8192
  s_add_u32 s64, s64, 16384
  v_add_u32 v11, s64, v8
  v_add_u32 v12, s64, v9
  s_waitcnt lgkmcnt(0)
  v_mfma_f32_16x16x32_bf16 v[176:179], v[16:19], v[128:131], 0
  ds_read_b64_tr_b16 v[152:153], v11 offset:0
  ds_read_b64_tr_b16 v[154:155], v11 offset:1024
  ds_read_b64_tr_b16 v[156:157], v12 offset:0
  ds_read_b64_tr_b16 v[158:159], v12 offset:1024
  v_mfma_f32_16x16x32_bf16 v[184:187], v[20:23], v[128:131], 0
  ds_read_b64_tr_b16 v[164:165], v11 offset:4096
  ds_read_b64_tr_b16 v[166:167], v11 offset:5120
  ds_read_b64_tr_b16 v[168:169], v12 offset:4096
  ds_read_b64_tr_b16 v[170:171], v12 offset:5120
  v_mfma_f32_16x16x32_bf16 v[180:183], v[16:19], v[132:135], 0
  ds_read_b128 v[32:35], v6 offset:8192
  ds_read_b128 v[36:39], v6 offset:10240
  ds_read_b128 v[40:43], v7 offset:8192
  ds_read_b128 v[44:47], v7 offset:10240
  v_mfma_f32_16x16x32_bf16 v[188:191], v[20:23], v[132:135], 0
  v_mfma_f32_16x16x32_bf16 v[176:179], v[24:27], v[140:143], v[176:179]
  v_mfma_f32_16x16x32_bf16 v[184:187], v[28:31], v[140:143], v[184:187]
  v_mfma_f32_16x16x32_bf16 v[180:183], v[24:27], v[144:147], v[180:183]
  v_mfma_f32_16x16x32_bf16 v[188:191], v[28:31], v[144:147], v[188:191]
  s_mul_i32 s64, s47, 8192
  s_add_u32 s64, s64, 32768
  v_add_u32 v11, s64, v8
  v_add_u32 v12, s64, v9
  s_waitcnt vmcnt(9) lgkmcnt(0)
  s_barrier
  v_mfma_f32_16x16x32_bf16 v[176:179], v[32:35], v[152:155], v[176:179]
  ds_read_b64_tr_b16 v[128:129], v11 offset:0
  ds_read_b64_tr_b16 v[130:131], v11 offset:1024
  ds_read_b64_tr_b16 v[132:133], v12 offset:0
  ds_read_b64_tr_b16 v[134:135], v12 offset:1024
  v_mfma_f32_16x16x32_bf16 v[184:187], v[36:39], v[152:155], v[184:187]
  ds_read_b64_tr_b16 v[140:141], v11 offset:4096
  ds_read_b64_tr_b16 v[142:143], v11 offset:5120
  ds_read_b64_tr_b16 v[144:145], v12 offset:4096
  ds_read_b64_tr_b16 v[146:147], v12 offset:5120
  v_mfma_f32_16x16x32_bf16 v[180:183], v[32:35], v[156:159], v[180:183]
  ds_read_b128 v[48:51], v6 offset:16384
  ds_read_b128 v[52:55], v6 offset:18432
  ds_read_b128 v[56:59], v7 offset:16384
  ds_read_b128 v[60:63], v7 offset:18432
  v_mfma_f32_16x16x32_bf16 v[188:191], v[36:39], v[156:159], v[188:191]
  s_add_u32 m0, s46, 0
  s_add_u32 s61, s48, 1378048
  buffer_load_dwordx4 v1, s[12:15], s61 offen lds
  v_mfma_f32_16x16x32_bf16 v[176:179], v[40:43], v[164:167], v[176:179]
  s_add_u32 m0, s46, 8192
  s_add_u32 s61, s48, 1378176
  buffer_load_dwordx4 v1, s[12:15], s61 offen lds
  v_mfma_f32_16x16x32_bf16 v[184:187], v[44:47], v[164:167], v[184:187]
  s_add_u32 m0, s46, 98304
  s_add_u32 s61, s49, 896
  buffer_load_dwordx4 v2, s[8:11], s61 offen lds
  v_mfma_f32_16x16x32_bf16 v[180:183], v[40:43], v[168:171], v[180:183]
  v_mfma_f32_16x16x32_bf16 v[188:191], v[44:47], v[168:171], v[188:191]
  s_mul_i32 s64, s47, 8192
  s_add_u32 s64, s64, 49152
  v_add_u32 v11, s64, v8
  v_add_u32 v12, s64, v9
  s_waitcnt lgkmcnt(0)
  v_mfma_f32_16x16x32_bf16 v[176:179], v[48:51], v[128:131], v[176:179]
  ds_read_b64_tr_b16 v[152:153], v11 offset:0
  ds_read_b64_tr_b16 v[154:155], v11 offset:1024
  ds_read_b64_tr_b16 v[156:157], v12 offset:0
  ds_read_b64_tr_b16 v[158:159], v12 offset:1024
  v_mfma_f32_16x16x32_bf16 v[184:187], v[52:55], v[128:131], v[184:187]
  ds_read_b64_tr_b16 v[164:165], v11 offset:4096
  ds_read_b64_tr_b16 v[166:167], v11 offset:5120
  ds_read_b64_tr_b16 v[168:169], v12 offset:4096
  ds_read_b64_tr_b16 v[170:171], v12 offset:5120
  v_mfma_f32_16x16x32_bf16 v[180:183], v[48:51], v[132:135], v[180:183]
  ds_read_b128 v[64:67], v6 offset:24576
  ds_read_b128 v[68:71], v6 offset:26624
  ds_read_b128 v[72:75], v7 offset:24576
  ds_read_b128 v[76:79], v7 offset:26624
  v_mfma_f32_16x16x32_bf16 v[188:191], v[52:55], v[132:135], v[188:191]
  s_add_u32 m0, s46, 16384
  s_add_u32 s61, s49, 1792
  buffer_load_dwordx4 v2, s[8:11], s61 offen lds
  v_mfma_f32_16x16x32_bf16 v[176:179], v[56:59], v[140:143], v[176:179]
  s_add_u32 m0, s46, 24576
  s_add_u32 s61, s49, 172928
  buffer_load_dwordx4 v2, s[8:11], s61 offen lds
  v_mfma_f32_16x16x32_bf16 v[184:187], v[60:63], v[140:143], v[184:187]
  s_add_u32 m0, s46, 106496
  s_add_u32 s61, s49, 173824
  buffer_load_dwordx4 v2, s[8:11], s61 offen lds
  v_mfma_f32_16x16x32_bf16 v[180:183], v[56:59], v[144:147], v[180:183]
  v_mfma_f32_16x16x32_bf16 v[188:191], v[60:63], v[144:147], v[188:191]
  s_mul_i32 s64, s47, 8192
  s_add_u32 s64, s64, 65536
  v_add_u32 v11, s64, v8
  v_add_u32 v12, s64, v9
  s_waitcnt vmcnt(11) lgkmcnt(0)
  s_barrier
  v_mfma_f32_16x16x32_bf16 v[176:179], v[64:67], v[152:155], v[176:179]
  ds_read_b64_tr_b16 v[128:129], v11 offset:0
  ds_read_b64_tr_b16 v[130:131], v11 offset:1024
  ds_read_b64_tr_b16 v[132:133], v12 offset:0
  ds_read_b64_tr_b16 v[134:135], v12 offset:1024
  v_mfma_f32_16x16x32_bf16 v[184:187], v[68:71], v[152:155], v[184:187]
  ds_read_b64_tr_b16 v[140:141], v11 offset:4096
  ds_read_b64_tr_b16 v[142:143], v11 offset:5120
  ds_read_b64_tr_b16 v[144:145], v12 offset:4096
  ds_read_b64_tr_b16 v[146:147], v12 offset:5120
  v_mfma_f32_16x16x32_bf16 v[180:183], v[64:67], v[156:159], v[180:183]
  ds_read_b128 v[80:83], v6 offset:32768
  ds_read_b128 v[84:87], v6 offset:34816
  ds_read_b128 v[88:91], v7 offset:32768
  ds_read_b128 v[92:95], v7 offset:34816
  v_mfma_f32_16x16x32_bf16 v[188:191], v[68:71], v[156:159], v[188:191]
  s_add_u32 m0, s46, 32768
  s_add_u32 s61, s49, 344960
  buffer_load_dwordx4 v2, s[8:11], s61 offen lds
  v_mfma_f32_16x16x32_bf16 v[176:179], v[72:75], v[164:167], v[176:179]
  s_add_u32 m0, s46, 40960
  s_add_u32 s61, s49, 345856
  buffer_load_dwordx4 v2, s[8:11], s61 offen lds
  v_mfma_f32_16x16x32_bf16 v[184:187], v[76:79], v[164:167], v[184:187]
  s_add_u32 m0, s46, 114688
  s_add_u32 s61, s49, 516992
  buffer_load_dwordx4 v2, s[8:11], s61 offen lds
  v_mfma_f32_16x16x32_bf16 v[180:183], v[72:75], v[168:171], v[180:183]
  v_mfma_f32_16x16x32_bf16 v[188:191], v[76:79], v[168:171], v[188:191]
  s_mul_i32 s64, s47, 8192
  s_add_u32 s64, s64, 81920
  v_add_u32 v11, s64, v8
  v_add_u32 v12, s64, v9
  s_waitcnt lgkmcnt(0)
  v_mfma_f32_16x16x32_bf16 v[176:179], v[80:83], v[128:131], v[176:179]
  ds_read_b64_tr_b16 v[152:153], v11 offset:0
  ds_read_b64_tr_b16 v[154:155], v11 offset:1024
  ds_read_b64_tr_b16 v[156:157], v12 offset:0
  ds_read_b64_tr_b16 v[158:159], v12 offset:1024
  v_mfma_f32_16x16x32_bf16 v[184:187], v[84:87], v[128:131], v[184:187]
  ds_read_b64_tr_b16 v[164:165], v11 offset:4096
  ds_read_b64_tr_b16 v[166:167], v11 offset:5120
  ds_read_b64_tr_b16 v[168:169], v12 offset:4096
  ds_read_b64_tr_b16 v[170:171], v12 offset:5120
  v_mfma_f32_16x16x32_bf16 v[180:183], v[80:83], v[132:135], v[180:183]
  ds_read_b128 v[96:99], v6 offset:40960
  ds_read_b128 v[100:103], v6 offset:43008
  ds_read_b128 v[104:107], v7 offset:40960
  ds_read_b128 v[108:111], v7 offset:43008
  v_mfma_f32_16x16x32_bf16 v[188:191], v[84:87], v[132:135], v[188:191]
  s_add_u32 m0, s46, 49152
  s_add_u32 s61, s49, 517888
  buffer_load_dwordx4 v2, s[8:11], s61 offen lds
  v_mfma_f32_16x16x32_bf16 v[176:179], v[88:91], v[140:143], v[176:179]
  s_add_u32 m0, s46, 57344
  s_add_u32 s61, s49, 689024
  buffer_load_dwordx4 v2, s[8:11], s61 offen lds
  v_mfma_f32_16x16x32_bf16 v[184:187], v[92:95], v[140:143], v[184:187]
  s_add_u32 m0, s46, 122880
  s_add_u32 s61, s49, 689920
  buffer_load_dwordx4 v2, s[8:11], s61 offen lds
  v_mfma_f32_16x16x32_bf16 v[180:183], v[88:91], v[144:147], v[180:183]
  v_mfma_f32_16x16x32_bf16 v[188:191], v[92:95], v[144:147], v[188:191]
  s_mul_i32 s64, s47, 8192
  s_add_u32 s64, s64, 0
  v_add_u32 v11, s64, v8
  v_add_u32 v12, s64, v9
  s_waitcnt vmcnt(8) lgkmcnt(0)
  s_barrier
  v_mfma_f32_16x16x32_bf16 v[176:179], v[96:99], v[152:155], v[176:179]
  ds_read_b64_tr_b16 v[128:129], v11 offset:0
  ds_read_b64_tr_b16 v[130:131], v11 offset:1024
  ds_read_b64_tr_b16 v[132:133], v12 offset:0
  ds_read_b64_tr_b16 v[134:135], v12 offset:1024
  v_mfma_f32_16x16x32_bf16 v[184:187], v[100:103], v[152:155], v[184:187]
  ds_read_b64_tr_b16 v[140:141], v11 offset:4096
  ds_read_b64_tr_b16 v[142:143], v11 offset:5120
  ds_read_b64_tr_b16 v[144:145], v12 offset:4096
  ds_read_b64_tr_b16 v[146:147], v12 offset:5120
  v_mfma_f32_16x16x32_bf16 v[180:183], v[96:99], v[156:159], v[180:183]
  ds_read_b128 v[112:115], v6 offset:49152
  ds_read_b128 v[116:119], v6 offset:51200
  ds_read_b128 v[120:123], v7 offset:49152
  ds_read_b128 v[124:127], v7 offset:51200
  v_mfma_f32_16x16x32_bf16 v[188:191], v[100:103], v[156:159], v[188:191]
  s_add_u32 m0, s46, 65536
  s_add_u32 s61, s49, 861056
  buffer_load_dwordx4 v2, s[8:11], s61 offen lds
  v_mfma_f32_16x16x32_bf16 v[176:179], v[104:107], v[164:167], v[176:179]
  s_add_u32 m0, s46, 73728
  s_add_u32 s61, s49, 861952
  buffer_load_dwordx4 v2, s[8:11], s61 offen lds
  v_mfma_f32_16x16x32_bf16 v[184:187], v[108:111], v[164:167], v[184:187]
  s_add_u32 m0, s46, 131072
  s_add_u32 s61, s49, 1033088
  buffer_load_dwordx4 v2, s[8:11], s61 offen lds
  v_mfma_f32_16x16x32_bf16 v[180:183], v[104:107], v[168:171], v[180:183]
  v_mfma_f32_16x16x32_bf16 v[188:191], v[108:111], v[168:171], v[188:191]
  v_add_u32 v11, 98304, v10
  v_add_u32 v12, 16384, v10
  s_waitcnt lgkmcnt(0)
  v_mfma_f32_16x16x32_bf16 v[176:179], v[112:115], v[128:131], v[176:179]
  ds_read_b64_tr_b16 v[152:153], v11 offset:0
  ds_read_b64_tr_b16 v[154:155], v11 offset:1024
  ds_read_b64_tr_b16 v[156:157], v12 offset:0
  ds_read_b64_tr_b16 v[158:159], v12 offset:1024
  v_mfma_f32_16x16x32_bf16 v[184:187], v[116:119], v[128:131], v[184:187]
  ds_read_b64_tr_b16 v[164:165], v11 offset:4096
  ds_read_b64_tr_b16 v[166:167], v11 offset:5120
  ds_read_b64_tr_b16 v[168:169], v12 offset:4096
  ds_read_b64_tr_b16 v[170:171], v12 offset:5120
  v_mfma_f32_16x16x32_bf16 v[180:183], v[112:115], v[132:135], v[180:183]
  s_add_u32 m0, s46, 81920
  s_add_u32 s61, s49, 1033984
  buffer_load_dwordx4 v2, s[8:11], s61 offen lds
  v_mfma_f32_16x16x32_bf16 v[188:191], v[116:119], v[132:135], v[188:191]
  s_add_u32 m0, s46, 90112
  s_add_u32 s61, s48, 0
  buffer_load_dwordx4 v1, s[12:15], s61 offen lds
  v_mfma_f32_16x16x32_bf16 v[176:179], v[120:123], v[140:143], v[176:179]
  s_add_u32 m0, s46, 139264
  s_add_u32 s61, s48, 128
  buffer_load_dwordx4 v1, s[12:15], s61 offen lds
  v_mfma_f32_16x16x32_bf16 v[184:187], v[124:127], v[140:143], v[184:187]
  v_mfma_f32_16x16x32_bf16 v[180:183], v[120:123], v[144:147], v[180:183]
  v_mfma_f32_16x16x32_bf16 v[188:191], v[124:127], v[144:147], v[188:191]
  v_add_u32 v11, 24576, v10
  v_add_u32 v12, 106496, v10
  s_lshl_b32 s64, s45, 3
  s_xor_b32 s64, s64, s41
  s_lshl_b32 s64, s64, 2
  s_add_u32 s64, s64, s44
  s_lshl_b32 s64, s64, 16
  s_bfe_u32 s65, s41, 65539
  s_lshl_b32 s65, s65, 11
  s_add_u32 s64, s64, s65
  s_lshl_b32 s65, s42, 13
  s_add_u32 s62, s64, s65
  v_lshrrev_b32 v13, 5, v0
  v_lshlrev_b32 v13, 12, v13
  v_and_b32 v4, 30, v0
  v_lshl_add_u32 v13, v4, 6, v13
  buffer_load_dword v4, v13, s[20:23], s62 offen
  v_pk_mul_f32 v[216:217], v[176:177], v[176:177]
  v_pk_mul_f32 v[218:219], v[178:179], v[178:179]
  v_pk_mul_f32 v[220:221], v[180:181], v[180:181]
  v_pk_mul_f32 v[222:223], v[182:183], v[182:183]
  v_pk_mul_f32 v[224:225], v[184:185], v[184:185]
  v_pk_mul_f32 v[226:227], v[186:187], v[186:187]
  v_pk_mul_f32 v[228:229], v[188:189], v[188:189]
  v_pk_mul_f32 v[230:231], v[190:191], v[190:191]
  v_pk_fma_f32 v[216:217], v[216:217], v[254:255], v[252:253]
  v_pk_fma_f32 v[218:219], v[218:219], v[254:255], v[252:253]
  v_pk_fma_f32 v[220:221], v[220:221], v[254:255], v[252:253]
  v_pk_fma_f32 v[222:223], v[222:223], v[254:255], v[252:253]
  v_pk_fma_f32 v[224:225], v[224:225], v[254:255], v[252:253]
  v_pk_fma_f32 v[226:227], v[226:227], v[254:255], v[252:253]
  v_pk_fma_f32 v[228:229], v[228:229], v[254:255], v[252:253]
  v_pk_fma_f32 v[230:231], v[230:231], v[254:255], v[252:253]
  v_pk_mul_f32 v[216:217], v[216:217], v[176:177]
  v_pk_mul_f32 v[218:219], v[218:219], v[178:179]
  v_pk_mul_f32 v[220:221], v[220:221], v[180:181]
  v_pk_mul_f32 v[222:223], v[222:223], v[182:183]
  v_pk_mul_f32 v[224:225], v[224:225], v[184:185]
  v_pk_mul_f32 v[226:227], v[226:227], v[186:187]
  v_pk_mul_f32 v[228:229], v[228:229], v[188:189]
  v_pk_mul_f32 v[230:231], v[230:231], v[190:191]
  v_exp_f32 v216, v216
  v_exp_f32 v217, v217
  v_exp_f32 v218, v218
  v_exp_f32 v219, v219
  v_exp_f32 v220, v220
  v_exp_f32 v221, v221
  v_exp_f32 v222, v222
  v_exp_f32 v223, v223
  v_exp_f32 v224, v224
  v_exp_f32 v225, v225
  v_exp_f32 v226, v226
  v_exp_f32 v227, v227
  v_exp_f32 v228, v228
  v_exp_f32 v229, v229
  v_exp_f32 v230, v230
  v_exp_f32 v231, v231
  v_pk_add_f32 v[216:217], v[216:217], 1.0 op_sel_hi:[1,0]
  v_pk_add_f32 v[218:219], v[218:219], 1.0 op_sel_hi:[1,0]
  v_pk_add_f32 v[220:221], v[220:221], 1.0 op_sel_hi:[1,0]
  v_pk_add_f32 v[222:223], v[222:223], 1.0 op_sel_hi:[1,0]
  v_pk_add_f32 v[224:225], v[224:225], 1.0 op_sel_hi:[1,0]
  v_pk_add_f32 v[226:227], v[226:227], 1.0 op_sel_hi:[1,0]
  v_pk_add_f32 v[228:229], v[228:229], 1.0 op_sel_hi:[1,0]
  v_pk_add_f32 v[230:231], v[230:231], 1.0 op_sel_hi:[1,0]
  v_rcp_f32 v216, v216
  v_rcp_f32 v217, v217
  v_rcp_f32 v218, v218
  v_rcp_f32 v219, v219
  v_rcp_f32 v220, v220
  v_rcp_f32 v221, v221
  v_rcp_f32 v222, v222
  v_rcp_f32 v223, v223
  v_rcp_f32 v224, v224
  v_rcp_f32 v225, v225
  v_rcp_f32 v226, v226
  v_rcp_f32 v227, v227
  v_rcp_f32 v228, v228
  v_rcp_f32 v229, v229
  v_rcp_f32 v230, v230
  v_rcp_f32 v231, v231
  v_pk_mul_f32 v[176:177], v[176:177], v[216:217]
  v_pk_mul_f32 v[178:179], v[178:179], v[218:219]
  v_pk_mul_f32 v[180:181], v[180:181], v[220:221]
  v_pk_mul_f32 v[182:183], v[182:183], v[222:223]
  v_pk_mul_f32 v[184:185], v[184:185], v[224:225]
  v_pk_mul_f32 v[186:187], v[186:187], v[226:227]
  v_pk_mul_f32 v[188:189], v[188:189], v[228:229]
  v_pk_mul_f32 v[190:191], v[190:191], v[230:231]
  v_pk_add_f32 v[232:233], v[176:177], v[180:181]
  v_pk_mul_f32 v[240:241], v[176:177], v[176:177]
  v_pk_add_f32 v[234:235], v[178:179], v[182:183]
  v_pk_mul_f32 v[242:243], v[178:179], v[178:179]
  v_pk_add_f32 v[236:237], v[184:185], v[188:189]
  v_pk_mul_f32 v[244:245], v[184:185], v[184:185]
  v_pk_add_f32 v[238:239], v[186:187], v[190:191]
  v_pk_mul_f32 v[246:247], v[186:187], v[186:187]
  v_pk_fma_f32 v[240:241], v[180:181], v[180:181], v[240:241]
  v_pk_fma_f32 v[242:243], v[182:183], v[182:183], v[242:243]
  v_pk_fma_f32 v[244:245], v[188:189], v[188:189], v[244:245]
  v_pk_fma_f32 v[246:247], v[190:191], v[190:191], v[246:247]
  v_add_f32_dpp v216, v232, v232 row_ror:8 row_mask:0xf bank_mask:0x3
  v_add_f32_dpp v217, v233, v233 row_ror:8 row_mask:0xf bank_mask:0x3
  v_add_f32_dpp v218, v234, v234 row_ror:8 row_mask:0xf bank_mask:0x3
  v_add_f32_dpp v219, v235, v235 row_ror:8 row_mask:0xf bank_mask:0x3
  v_add_f32_dpp v216, v236, v236 row_ror:8 row_mask:0xf bank_mask:0xc
  v_add_f32_dpp v217, v237, v237 row_ror:8 row_mask:0xf bank_mask:0xc
  v_add_f32_dpp v218, v238, v238 row_ror:8 row_mask:0xf bank_mask:0xc
  v_add_f32_dpp v219, v239, v239 row_ror:8 row_mask:0xf bank_mask:0xc
  v_add_f32_dpp v220, v240, v240 row_ror:8 row_mask:0xf bank_mask:0x3
  v_add_f32_dpp v221, v241, v241 row_ror:8 row_mask:0xf bank_mask:0x3
  v_add_f32_dpp v222, v242, v242 row_ror:8 row_mask:0xf bank_mask:0x3
  v_add_f32_dpp v223, v243, v243 row_ror:8 row_mask:0xf bank_mask:0x3
  v_add_f32_dpp v220, v244, v244 row_ror:8 row_mask:0xf bank_mask:0xc
  v_add_f32_dpp v221, v245, v245 row_ror:8 row_mask:0xf bank_mask:0xc
  v_add_f32_dpp v222, v246, v246 row_ror:8 row_mask:0xf bank_mask:0xc
  v_add_f32_dpp v223, v247, v247 row_ror:8 row_mask:0xf bank_mask:0xc
  v_add_f32_dpp v224, v216, v216 row_ror:12 row_mask:0xf bank_mask:0x5
  v_add_f32_dpp v225, v217, v217 row_ror:12 row_mask:0xf bank_mask:0x5
  s_nop 0
  v_add_f32_dpp v224, v218, v218 row_ror:4 row_mask:0xf bank_mask:0xa
  v_add_f32_dpp v225, v219, v219 row_ror:4 row_mask:0xf bank_mask:0xa
  v_add_f32_dpp v226, v220, v220 row_ror:12 row_mask:0xf bank_mask:0x5
  v_add_f32_dpp v227, v221, v221 row_ror:12 row_mask:0xf bank_mask:0x5
  s_nop 0
  v_add_f32_dpp v226, v222, v222 row_ror:4 row_mask:0xf bank_mask:0xa
  v_add_f32_dpp v227, v223, v223 row_ror:4 row_mask:0xf bank_mask:0xa
  v_lshrrev_b32 v220, 2, v0
  v_lshlrev_b32 v220, 4, v220
  v_and_b32 v221, 1, v0
  v_add_f32_dpp v224, v224, v224 quad_perm:[1,0,3,2] row_mask:0xf bank_mask:0xf
  v_add_f32_dpp v225, v225, v225 quad_perm:[1,0,3,2] row_mask:0xf bank_mask:0xf
  v_add_f32_dpp v226, v226, v226 quad_perm:[1,0,3,2] row_mask:0xf bank_mask:0xf
  v_add_f32_dpp v227, v227, v227 quad_perm:[1,0,3,2] row_mask:0xf bank_mask:0xf
  v_lshl_add_u32 v220, v221, 3, v220
  v_bfe_u32 v221, v0, 1, 1
  v_add_f32_dpp v224, v224, v224 quad_perm:[2,3,0,1] row_mask:0xf bank_mask:0xf
  v_add_f32_dpp v225, v225, v225 quad_perm:[2,3,0,1] row_mask:0xf bank_mask:0xf
  v_add_f32_dpp v226, v226, v226 quad_perm:[2,3,0,1] row_mask:0xf bank_mask:0xf
  v_add_f32_dpp v227, v227, v227 quad_perm:[2,3,0,1] row_mask:0xf bank_mask:0xf
  s_mov_b32 s66, 0xaaaaaaaa
  s_mov_b32 s67, 0xaaaaaaaa
  s_mov_b32 vcc_lo, 0xcccccccc
  s_mov_b32 vcc_hi, 0xcccccccc
  s_lshl_b32 s64, s44, 9
  s_lshl_b32 s65, s45, 8
  s_add_u32 s64, s64, s65
  s_add_u32 s64, s64, 155648
  v_lshl_add_u32 v220, v221, 2, v220
  v_cndmask_b32_e64 v216, v224, v225, s[66:67]
  v_cndmask_b32_e64 v218, v226, v227, s[66:67]
  v_add_u32 v220, s64, v220
  v_cndmask_b32 v216, v216, v218, vcc
  ds_write_b32 v220, v216
  s_waitcnt vmcnt(11) lgkmcnt(0)
  s_barrier
  s_cmp_lg_u32 s40, 0
  s_cbranch_scc1 OW_2
  v_lshlrev_b32 v14, 3, v0
  v_add_u32 v14, 155648, v14
  ds_read_b64 v[216:217], v14
  ds_read_b64 v[218:219], v14 offset:512
  ds_read_b64 v[220:221], v14 offset:1024
  ds_read_b64 v[222:223], v14 offset:1536
  s_lshl_b32 s64, s41, 3
  s_add_u32 s64, s64, s42
  s_lshl_b32 s64, s64, 10
  s_add_u32 s64, s64, 524288
  s_waitcnt lgkmcnt(0)
  v_pk_add_f32 v[216:217], v[216:217], v[218:219]
  v_pk_add_f32 v[220:221], v[220:221], v[222:223]
  v_mov_b32 v218, s43
  v_mov_b32 v219, s100
  v_pk_add_f32 v[216:217], v[216:217], v[220:221]
  buffer_store_dwordx4 v[216:219], v5, s[16:19], s64 offen sc1
  s_nop 4
OW_2:
  v_mfma_f32_16x16x32_bf16 v[192:195], v[16:19], v[152:155], 0
  ds_read_b64_tr_b16 v[128:129], v11 offset:0
  ds_read_b64_tr_b16 v[130:131], v11 offset:1024
  ds_read_b64_tr_b16 v[132:133], v12 offset:0
  ds_read_b64_tr_b16 v[134:135], v12 offset:1024
  v_mfma_f32_16x16x32_bf16 v[196:199], v[20:23], v[152:155], 0
  ds_read_b64_tr_b16 v[140:141], v11 offset:4096
  ds_read_b64_tr_b16 v[142:143], v11 offset:5120
  ds_read_b64_tr_b16 v[144:145], v12 offset:4096
  ds_read_b64_tr_b16 v[146:147], v12 offset:5120
  v_mfma_f32_16x16x32_bf16 v[200:203], v[16:19], v[156:159], 0
  s_add_u32 m0, s46, 0
  s_add_u32 s61, s48, 229376
  buffer_load_dwordx4 v1, s[12:15], s61 offen lds
  v_mfma_f32_16x16x32_bf16 v[204:207], v[20:23], v[156:159], 0
  s_add_u32 m0, s46, 8192
  s_add_u32 s61, s48, 229504
  buffer_load_dwordx4 v1, s[12:15], s61 offen lds
  v_mfma_f32_16x16x32_bf16 v[192:195], v[24:27], v[164:167], v[192:195]
  s_add_u32 m0, s46, 147456
  s_add_u32 s61, s48, 458752
  buffer_load_dwordx4 v1, s[12:15], s61 offen lds
  v_mfma_f32_16x16x32_bf16 v[196:199], v[28:31], v[164:167], v[196:199]
  v_mfma_f32_16x16x32_bf16 v[200:203], v[24:27], v[168:171], v[200:203]
  v_mfma_f32_16x16x32_bf16 v[204:207], v[28:31], v[168:171], v[204:207]
  v_add_u32 v11, 32768, v10
  v_add_u32 v12, 40960, v10
  s_waitcnt lgkmcnt(0)
  v_mfma_f32_16x16x32_bf16 v[192:195], v[32:35], v[128:131], v[192:195]
  ds_read_b64_tr_b16 v[152:153], v11 offset:0
  ds_read_b64_tr_b16 v[154:155], v11 offset:1024
  ds_read_b64_tr_b16 v[156:157], v12 offset:0
  ds_read_b64_tr_b16 v[158:159], v12 offset:1024
  v_mfma_f32_16x16x32_bf16 v[196:199], v[36:39], v[128:131], v[196:199]
  ds_read_b64_tr_b16 v[164:165], v11 offset:4096
  ds_read_b64_tr_b16 v[166:167], v11 offset:5120
  ds_read_b64_tr_b16 v[168:169], v12 offset:4096
  ds_read_b64_tr_b16 v[170:171], v12 offset:5120
  v_mfma_f32_16x16x32_bf16 v[200:203], v[32:35], v[132:135], v[200:203]
  s_add_u32 m0, s46, 98304
  s_add_u32 s61, s48, 458880
  buffer_load_dwordx4 v1, s[12:15], s61 offen lds
  v_mfma_f32_16x16x32_bf16 v[204:207], v[36:39], v[132:135], v[204:207]
  s_add_u32 m0, s46, 16384
  s_add_u32 s61, s48, 688128
  buffer_load_dwordx4 v1, s[12:15], s61 offen lds
  v_mfma_f32_16x16x32_bf16 v[192:195], v[40:43], v[140:143], v[192:195]
  v_mfma_f32_16x16x32_bf16 v[196:199], v[44:47], v[140:143], v[196:199]
  v_mfma_f32_16x16x32_bf16 v[200:203], v[40:43], v[144:147], v[200:203]
  v_mfma_f32_16x16x32_bf16 v[204:207], v[44:47], v[144:147], v[204:207]
  v_add_u32 v11, 114688, v10
  v_add_u32 v12, 49152, v10
  s_waitcnt vmcnt(12) lgkmcnt(0)
  s_barrier
  v_mfma_f32_16x16x32_bf16 v[192:195], v[48:51], v[152:155], v[192:195]
  ds_read_b64_tr_b16 v[128:129], v11 offset:0
  ds_read_b64_tr_b16 v[130:131], v11 offset:1024
  ds_read_b64_tr_b16 v[132:133], v12 offset:0
  ds_read_b64_tr_b16 v[134:135], v12 offset:1024
  v_mfma_f32_16x16x32_bf16 v[196:199], v[52:55], v[152:155], v[196:199]
  ds_read_b64_tr_b16 v[140:141], v11 offset:4096
  ds_read_b64_tr_b16 v[142:143], v11 offset:5120
  ds_read_b64_tr_b16 v[144:145], v12 offset:4096
  ds_read_b64_tr_b16 v[146:147], v12 offset:5120
  v_mfma_f32_16x16x32_bf16 v[200:203], v[48:51], v[156:159], v[200:203]
  s_add_u32 m0, s46, 24576
  s_add_u32 s61, s48, 688256
  buffer_load_dwordx4 v1, s[12:15], s61 offen lds
  v_mfma_f32_16x16x32_bf16 v[204:207], v[52:55], v[156:159], v[204:207]
  s_add_u32 m0, s46, 106496
  s_add_u32 s61, s48, 917504
  buffer_load_dwordx4 v1, s[12:15], s61 offen lds
  v_mfma_f32_16x16x32_bf16 v[192:195], v[56:59], v[164:167], v[192:195]
  v_mfma_f32_16x16x32_bf16 v[196:199], v[60:63], v[164:167], v[196:199]
  v_mfma_f32_16x16x32_bf16 v[200:203], v[56:59], v[168:171], v[200:203]
  v_mfma_f32_16x16x32_bf16 v[204:207], v[60:63], v[168:171], v[204:207]
  v_add_u32 v11, 57344, v10
  v_add_u32 v12, 122880, v10
  s_waitcnt lgkmcnt(0)
  s_cmp_lg_u32 s40, 1
  s_cbranch_scc1 OW_3
  s_lshl_b32 s66, s41, 13
  s_add_u32 s66, s66, 524288
  s_add_u32 s67, s66, 4096
  buffer_load_dwordx4 v[216:219], v5, s[16:19], s66 offen offset:0 sc1
  buffer_load_dwordx4 v[220:223], v5, s[16:19], s66 offen offset:1024 sc1
  buffer_load_dwordx4 v[224:227], v5, s[16:19], s66 offen offset:2048 sc1
  buffer_load_dwordx4 v[228:231], v5, s[16:19], s66 offen offset:3072 sc1
  buffer_load_dwordx4 v[232:235], v5, s[16:19], s67 offen offset:0 sc1
  buffer_load_dwordx4 v[236:239], v5, s[16:19], s67 offen offset:1024 sc1
  buffer_load_dwordx4 v[240:243], v5, s[16:19], s67 offen offset:2048 sc1
  s_nop 4
OW_3:
  v_mfma_f32_16x16x32_bf16 v[192:195], v[64:67], v[128:131], v[192:195]
  ds_read_b64_tr_b16 v[152:153], v11 offset:0
  ds_read_b64_tr_b16 v[154:155], v11 offset:1024
  ds_read_b64_tr_b16 v[156:157], v12 offset:0
  ds_read_b64_tr_b16 v[158:159], v12 offset:1024
  v_mfma_f32_16x16x32_bf16 v[196:199], v[68:71], v[128:131], v[196:199]
  ds_read_b64_tr_b16 v[164:165], v11 offset:4096
  ds_read_b64_tr_b16 v[166:167], v11 offset:5120
  ds_read_b64_tr_b16 v[168:169], v12 offset:4096
  ds_read_b64_tr_b16 v[170:171], v12 offset:5120
  v_mfma_f32_16x16x32_bf16 v[200:203], v[64:67], v[132:135], v[200:203]
  s_add_u32 m0, s46, 32768
  s_add_u32 s61, s48, 917632
  buffer_load_dwordx4 v1, s[12:15], s61 offen lds
  v_mfma_f32_16x16x32_bf16 v[204:207], v[68:71], v[132:135], v[204:207]
  s_add_u32 m0, s46, 40960
  s_add_u32 s61, s48, 1146880
  buffer_load_dwordx4 v1, s[12:15], s61 offen lds
  v_mfma_f32_16x16x32_bf16 v[192:195], v[72:75], v[140:143], v[192:195]
  v_mfma_f32_16x16x32_bf16 v[196:199], v[76:79], v[140:143], v[196:199]
  v_mfma_f32_16x16x32_bf16 v[200:203], v[72:75], v[144:147], v[200:203]
  v_mfma_f32_16x16x32_bf16 v[204:207], v[76:79], v[144:147], v[204:207]
  v_add_u32 v11, 65536, v10
  v_add_u32 v12, 73728, v10
  s_waitcnt vmcnt(12) lgkmcnt(0)
  s_cmp_lg_u32 s40, 1
  s_cbranch_scc1 OW_4
  s_movk_i32 s62, 0x1000
  s_waitcnt vmcnt(2)
SR_5:
  v_max3_u32 v244, v218, v222, v226
  v_max3_u32 v244, v244, v230, v234
  v_max3_u32 v244, v244, v238, v242
  v_min3_u32 v245, v218, v222, v226
  v_min3_u32 v245, v245, v230, v234
  v_min3_u32 v245, v245, v238, v242
  v_max3_u32 v246, v219, v223, v227
  v_max3_u32 v246, v246, v231, v235
  v_max3_u32 v246, v246, v239, v243
  v_min3_u32 v247, v219, v223, v227
  v_min3_u32 v247, v247, v231, v235
  v_min3_u32 v247, v247, v239, v243
  v_xor_b32 v246, s100, v246
  v_xor_b32 v247, s100, v247
  v_xor_b32 v244, s43, v244
  v_xor_b32 v245, s43, v245
  v_or_b32 v246, v246, v247
  v_and_b32 v247, -16, v246
  v_or3_b32 v244, v244, v245, v247
  v_cmp_ne_u32 vcc, 0, v244
  s_nop 1
  s_cbranch_vccz SK_6
  s_sub_u32 s62, s62, 1
  s_cbranch_scc1 SK_6
  s_sleep 1
  s_lshl_b32 s66, s41, 13
  s_add_u32 s66, s66, 524288
  s_add_u32 s67, s66, 4096
  buffer_load_dwordx4 v[216:219], v5, s[16:19], s66 offen offset:0 sc1
  buffer_load_dwordx4 v[220:223], v5, s[16:19], s66 offen offset:1024 sc1
  buffer_load_dwordx4 v[224:227], v5, s[16:19], s66 offen offset:2048 sc1
  buffer_load_dwordx4 v[228:231], v5, s[16:19], s66 offen offset:3072 sc1
  buffer_load_dwordx4 v[232:235], v5, s[16:19], s67 offen offset:0 sc1
  buffer_load_dwordx4 v[236:239], v5, s[16:19], s67 offen offset:1024 sc1
  buffer_load_dwordx4 v[240:243], v5, s[16:19], s67 offen offset:2048 sc1
  s_waitcnt vmcnt(0)
  s_branch SR_5
SK_6:
  v_add_f32 v216, v216, v220
  v_add_f32 v224, v224, v228
  v_add_f32 v232, v232, v236
  v_add_f32 v216, v216, v240
  v_add_f32 v224, v224, v232
  v_add_f32 v216, v216, v224
  v_add_f32 v217, v217, v221
  v_add_f32 v225, v225, v229
  v_add_f32 v233, v233, v237
  v_add_f32 v217, v217, v241
  v_add_f32 v225, v225, v233
  v_add_f32 v217, v217, v225
  v_mul_f32 v216, 0x3a924925, v216
  v_mul_f32 v217, 0x3a924925, v217
  v_fma_f32 v217, -v216, v216, v217
  v_max_f32 v217, 0, v217
  v_add_f32 v217, 0x3727c5ac, v217
  v_rsq_f32 v217, v217
  v_lshlrev_b32 v14, 2, v0
  v_add_u32 v14, 157696, v14
  v_mul_f32 v216, -v216, v217
  ds_write2_b32 v14, v217, v216 offset1:64
  ds_write_b32 v14, v246 offset:512
  s_waitcnt lgkmcnt(0)
  s_nop 4
OW_4:
  s_barrier
  v_lshrrev_b32 v14, 4, v0
  v_lshlrev_b32 v14, 5, v14
  s_lshl_b32 s64, s45, 7
  s_add_u32 s64, s64, 157696
  v_add_u32 v14, s64, v14
  ds_read_b128 v[216:219], v14
  ds_read_b128 v[220:223], v14 offset:16
  ds_read_b128 v[224:227], v14 offset:256
  ds_read_b128 v[228:231], v14 offset:272
  ds_read_b32 v246, v14 offset:512
  s_lshl_b32 s66, s41, 12
  s_add_u32 s66, s66, s56
  v_mfma_f32_16x16x32_bf16 v[192:195], v[80:83], v[152:155], v[192:195]
  ds_read_b64_tr_b16 v[128:129], v11 offset:0
  ds_read_b64_tr_b16 v[130:131], v11 offset:1024
  ds_read_b64_tr_b16 v[132:133], v12 offset:0
  ds_read_b64_tr_b16 v[134:135], v12 offset:1024
  v_mfma_f32_16x16x32_bf16 v[196:199], v[84:87], v[152:155], v[196:199]
  ds_read_b64_tr_b16 v[140:141], v11 offset:4096
  ds_read_b64_tr_b16 v[142:143], v11 offset:5120
  ds_read_b64_tr_b16 v[144:145], v12 offset:4096
  ds_read_b64_tr_b16 v[146:147], v12 offset:5120
  s_waitcnt lgkmcnt(8)
  v_mfma_f32_16x16x32_bf16 v[200:203], v[80:83], v[156:159], v[200:203]
  s_add_u32 m0, s46, 114688
  s_add_u32 s61, s48, 1147008
  buffer_load_dwordx4 v1, s[12:15], s61 offen lds
  v_fma_f32 v176, v176, v216, v224
  v_fma_f32 v177, v177, v217, v225
  v_fma_f32 v178, v178, v218, v226
  v_fma_f32 v179, v179, v219, v227
  v_fma_f32 v184, v184, v220, v228
  v_mfma_f32_16x16x32_bf16 v[204:207], v[84:87], v[156:159], v[204:207]
  s_add_u32 m0, s46, 49152
  s_add_u32 s61, s48, 1376256
  buffer_load_dwordx4 v1, s[12:15], s61 offen lds
  v_fma_f32 v185, v185, v221, v229
  v_fma_f32 v186, v186, v222, v230
  v_fma_f32 v187, v187, v223, v231
  v_cvt_pk_bf16_f32 v232, v176, v177
  v_cvt_pk_bf16_f32 v233, v178, v179
  v_mfma_f32_16x16x32_bf16 v[192:195], v[88:91], v[164:167], v[192:195]
  v_cvt_pk_bf16_f32 v234, v184, v185
  v_cvt_pk_bf16_f32 v235, v186, v187
  buffer_store_dwordx4 v[232:235], v5, s[16:19], s66 offen offset:0 sc1
  v_fma_f32 v180, v180, v216, v224
  v_fma_f32 v181, v181, v217, v225
  v_mfma_f32_16x16x32_bf16 v[196:199], v[92:95], v[164:167], v[196:199]
  v_fma_f32 v182, v182, v218, v226
  v_fma_f32 v183, v183, v219, v227
  v_fma_f32 v188, v188, v220, v228
  v_fma_f32 v189, v189, v221, v229
  v_fma_f32 v190, v190, v222, v230
  v_mfma_f32_16x16x32_bf16 v[200:203], v[88:91], v[168:171], v[200:203]
  v_fma_f32 v191, v191, v223, v231
  v_cvt_pk_bf16_f32 v236, v180, v181
  v_cvt_pk_bf16_f32 v237, v182, v183
  v_cvt_pk_bf16_f32 v238, v188, v189
  v_cvt_pk_bf16_f32 v239, v190, v191
  v_mfma_f32_16x16x32_bf16 v[204:207], v[92:95], v[168:171], v[204:207]
  buffer_store_dwordx4 v[236:239], v5, s[16:19], s66 offen offset:1024 sc1
  v_readfirstlane_b32 s101, v246
  v_add_u32 v11, 131072, v10
  v_add_u32 v12, 81920, v10
  s_waitcnt lgkmcnt(0)
  v_mfma_f32_16x16x32_bf16 v[192:195], v[96:99], v[128:131], v[192:195]
  ds_read_b64_tr_b16 v[152:153], v11 offset:0
  ds_read_b64_tr_b16 v[154:155], v11 offset:1024
  ds_read_b64_tr_b16 v[156:157], v12 offset:0
  ds_read_b64_tr_b16 v[158:159], v12 offset:1024
  v_mfma_f32_16x16x32_bf16 v[196:199], v[100:103], v[128:131], v[196:199]
  ds_read_b64_tr_b16 v[164:165], v11 offset:4096
  ds_read_b64_tr_b16 v[166:167], v11 offset:5120
  ds_read_b64_tr_b16 v[168:169], v12 offset:4096
  ds_read_b64_tr_b16 v[170:171], v12 offset:5120
  v_mfma_f32_16x16x32_bf16 v[200:203], v[96:99], v[132:135], v[200:203]
  s_add_u32 m0, s46, 57344
  s_add_u32 s61, s48, 1376384
  buffer_load_dwordx4 v1, s[12:15], s61 offen lds
  v_mfma_f32_16x16x32_bf16 v[204:207], v[100:103], v[132:135], v[204:207]
  s_add_u32 m0, s46, 122880
  s_add_u32 s61, s51, 0
  buffer_load_dwordx4 v3, s[20:23], s61 offen lds
  v_mfma_f32_16x16x32_bf16 v[192:195], v[104:107], v[140:143], v[192:195]
  v_mfma_f32_16x16x32_bf16 v[196:199], v[108:111], v[140:143], v[196:199]
  v_mfma_f32_16x16x32_bf16 v[200:203], v[104:107], v[144:147], v[200:203]
  v_mfma_f32_16x16x32_bf16 v[204:207], v[108:111], v[144:147], v[204:207]
  s_mul_i32 s64, s47, 49152
  s_add_u32 s64, s64, 90112
  v_add_u32 v11, s64, v8
  v_add_u32 v12, s64, v9
  s_waitcnt vmcnt(13) lgkmcnt(0)
  s_barrier
  v_mfma_f32_16x16x32_bf16 v[192:195], v[112:115], v[152:155], v[192:195]
  ds_read_b64_tr_b16 v[128:129], v11 offset:0
  ds_read_b64_tr_b16 v[130:131], v11 offset:1024
  ds_read_b64_tr_b16 v[132:133], v12 offset:0
  ds_read_b64_tr_b16 v[134:135], v12 offset:1024
  v_mfma_f32_16x16x32_bf16 v[196:199], v[116:119], v[152:155], v[196:199]
  ds_read_b64_tr_b16 v[140:141], v11 offset:4096
  ds_read_b64_tr_b16 v[142:143], v11 offset:5120
  ds_read_b64_tr_b16 v[144:145], v12 offset:4096
  ds_read_b64_tr_b16 v[146:147], v12 offset:5120
  v_mfma_f32_16x16x32_bf16 v[200:203], v[112:115], v[156:159], v[200:203]
  s_add_u32 m0, s46, 65536
  s_add_u32 s61, s50, 0
  buffer_load_dwordx4 v3, s[20:23], s61 offen lds
  s_add_u32 s64, s46, 155648
  v_add_u32 v212, s64, v5
  v_mfma_f32_16x16x32_bf16 v[204:207], v[116:119], v[156:159], v[204:207]
  s_add_u32 m0, s46, 73728
  s_add_u32 s61, s51, 128
  buffer_load_dwordx4 v3, s[20:23], s61 offen lds
  ds_write_b128 v212, v[208:211]
  v_mfma_f32_16x16x32_bf16 v[192:195], v[120:123], v[164:167], v[192:195]
  v_mfma_f32_16x16x32_bf16 v[196:199], v[124:127], v[164:167], v[196:199]
  v_mfma_f32_16x16x32_bf16 v[200:203], v[120:123], v[168:171], v[200:203]
  v_mfma_f32_16x16x32_bf16 v[204:207], v[124:127], v[168:171], v[204:207]
  s_mul_i32 s64, s47, 8192
  s_add_u32 s64, s64, 0
  v_add_u32 v11, s64, v8
  v_add_u32 v12, s64, v9
  s_waitcnt lgkmcnt(0)
  v_mfma_f32_16x16x32_bf16 v[176:179], v[128:131], v[16:19], 0
  ds_read_b64_tr_b16 v[152:153], v11 offset:0
  ds_read_b64_tr_b16 v[154:155], v11 offset:1024
  ds_read_b64_tr_b16 v[156:157], v12 offset:0
  ds_read_b64_tr_b16 v[158:159], v12 offset:1024
  v_mfma_f32_16x16x32_bf16 v[184:187], v[128:131], v[20:23], 0
  ds_read_b64_tr_b16 v[164:165], v11 offset:4096
  ds_read_b64_tr_b16 v[166:167], v11 offset:5120
  ds_read_b64_tr_b16 v[168:169], v12 offset:4096
  ds_read_b64_tr_b16 v[170:171], v12 offset:5120
  v_mfma_f32_16x16x32_bf16 v[180:183], v[132:135], v[16:19], 0
  s_add_u32 m0, s46, 131072
  s_add_u32 s61, s50, 128
  buffer_load_dwordx4 v3, s[20:23], s61 offen lds
  s_lshl_b32 s68, s53, 16
  s_lshl_b32 s69, s52, 10
  s_add_u32 s68, s68, s69
  s_add_u32 s68, s68, 6553600
  v_cvt_pk_bf16_f32 v224, v200, v201
  v_mfma_f32_16x16x32_bf16 v[188:191], v[132:135], v[20:23], 0
  s_add_u32 m0, s46, 81920
  s_add_u32 s61, s51, 256
  buffer_load_dwordx4 v3, s[20:23], s61 offen lds
  v_cvt_pk_bf16_f32 v225, v202, v203
  v_cvt_pk_bf16_f32 v226, v204, v205
  v_cvt_pk_bf16_f32 v227, v206, v207
  v_or_b32 v227, 1, v227
  buffer_store_dwordx4 v[224:227], v5, s[16:19], s68 offen sc1
  v_mfma_f32_16x16x32_bf16 v[176:179], v[140:143], v[24:27], v[176:179]
  v_mul_f32 v216, 0x3fb8aa3b, v192
  v_mul_f32 v217, 0x3fb8aa3b, v193
  v_mul_f32 v218, 0x3fb8aa3b, v194
  v_mul_f32 v219, 0x3fb8aa3b, v195
  v_mul_f32 v220, 0x3fb8aa3b, v196
  v_mfma_f32_16x16x32_bf16 v[184:187], v[140:143], v[28:31], v[184:187]
  v_mul_f32 v221, 0x3fb8aa3b, v197
  v_mul_f32 v222, 0x3fb8aa3b, v198
  v_mul_f32 v223, 0x3fb8aa3b, v199
  v_exp_f32_e64 v216, v216 clamp
  v_exp_f32_e64 v217, v217 clamp
  v_mfma_f32_16x16x32_bf16 v[180:183], v[144:147], v[24:27], v[180:183]
  v_exp_f32_e64 v218, v218 clamp
  v_exp_f32_e64 v219, v219 clamp
  v_exp_f32_e64 v220, v220 clamp
  v_exp_f32_e64 v221, v221 clamp
  v_exp_f32_e64 v222, v222 clamp
  v_mfma_f32_16x16x32_bf16 v[188:191], v[144:147], v[28:31], v[188:191]
  v_exp_f32_e64 v223, v223 clamp
  v_max_f32 v192, 0, v192
  v_max_f32 v193, 0, v193
  v_max_f32 v194, 0, v194
  v_max_f32 v195, 0, v195
  s_mul_i32 s64, s47, -49152
  s_add_u32 s64, s64, 147456
  v_add_u32 v11, s64, v8
  v_add_u32 v12, s64, v9
  s_waitcnt vmcnt(14) lgkmcnt(0)
  s_waitcnt vmcnt(7)
  s_barrier
  s_cmp_lg_u32 s40, 2
  s_cbranch_scc1 OW_7
  s_lshl_b32 s64, s42, 5
  s_add_u32 s64, s64, s41
  s_lshl_b32 s64, s64, 7
  s_add_u32 s64, s64, 0
  s_mov_b64 exec, 1
  v_mov_b32 v14, s43
  buffer_store_dword v14, off, s[16:19], s64 sc1
  s_mov_b64 exec, -1
  s_nop 4
OW_7:
  v_mfma_f32_16x16x32_bf16 v[176:179], v[152:155], v[32:35], v[176:179]
  ds_read_b64_tr_b16 v[128:129], v11 offset:0
  ds_read_b64_tr_b16 v[130:131], v11 offset:1024
  ds_read_b64_tr_b16 v[132:133], v12 offset:0
  ds_read_b64_tr_b16 v[134:135], v12 offset:1024
  v_mfma_f32_16x16x32_bf16 v[184:187], v[152:155], v[36:39], v[184:187]
  ds_read_b64_tr_b16 v[140:141], v11 offset:4096
  ds_read_b64_tr_b16 v[142:143], v11 offset:5120
  ds_read_b64_tr_b16 v[144:145], v12 offset:4096
  ds_read_b64_tr_b16 v[146:147], v12 offset:5120
  v_mfma_f32_16x16x32_bf16 v[180:183], v[156:159], v[32:35], v[180:183]
  s_add_u32 m0, s46, 90112
  s_add_u32 s61, s50, 256
  buffer_load_dwordx4 v3, s[20:23], s61 offen lds
  v_max_f32 v196, 0, v196
  v_max_f32 v197, 0, v197
  v_max_f32 v198, 0, v198
  v_max_f32 v199, 0, v199
  v_add_f32 v192, v192, v216
  v_mfma_f32_16x16x32_bf16 v[188:191], v[156:159], v[36:39], v[188:191]
  s_add_u32 m0, s46, 139264
  s_add_u32 s61, s51, 384
  buffer_load_dwordx4 v3, s[20:23], s61 offen lds
  v_add_f32 v193, v193, v217
  v_add_f32 v194, v194, v218
  v_add_f32 v195, v195, v219
  v_add_f32 v196, v196, v220
  v_add_f32 v197, v197, v221
  v_mfma_f32_16x16x32_bf16 v[176:179], v[164:167], v[40:43], v[176:179]
  v_add_f32 v198, v198, v222
  v_add_f32 v199, v199, v223
  v_add_f32 v192, 0x358637bd, v192
  v_add_f32 v193, 0x358637bd, v193
  v_add_f32 v194, 0x358637bd, v194
  v_mfma_f32_16x16x32_bf16 v[184:187], v[164:167], v[44:47], v[184:187]
  v_add_f32 v195, 0x358637bd, v195
  v_add_f32 v196, 0x358637bd, v196
  v_add_f32 v197, 0x358637bd, v197
  v_add_f32 v198, 0x358637bd, v198
  v_add_f32 v199, 0x358637bd, v199
  v_mfma_f32_16x16x32_bf16 v[180:183], v[168:171], v[40:43], v[180:183]
  v_cvt_pk_bf16_f32 v228, v192, v193
  v_cvt_pk_bf16_f32 v229, v194, v195
  v_cvt_pk_bf16_f32 v230, v196, v197
  v_cvt_pk_bf16_f32 v231, v198, v199
  v_bfe_u32 v241, v0, 2, 2
  v_mfma_f32_16x16x32_bf16 v[188:191], v[168:171], v[44:47], v[188:191]
  v_lshlrev_b32 v241, 4, v241
  v_and_b32 v243, 3, v0
  v_lshl_add_u32 v241, v243, 1, v241
  s_lshl_b32 s63, s52, 6
  buffer_load_ushort v240, v241, s[24:27], s63 offen offset:0
  s_lshl_b32 s63, s52, 6
  buffer_load_ushort v242, v241, s[24:27], s63 offen offset:8
  s_mul_i32 s64, s47, 8192
  s_add_u32 s64, s64, 16384
  v_add_u32 v11, s64, v8
  v_add_u32 v12, s64, v9
  s_waitcnt lgkmcnt(0)
  v_mfma_f32_16x16x32_bf16 v[176:179], v[128:131], v[48:51], v[176:179]
  ds_read_b64_tr_b16 v[152:153], v11 offset:0
  ds_read_b64_tr_b16 v[154:155], v11 offset:1024
  ds_read_b64_tr_b16 v[156:157], v12 offset:0
  ds_read_b64_tr_b16 v[158:159], v12 offset:1024
  v_mfma_f32_16x16x32_bf16 v[184:187], v[128:131], v[52:55], v[184:187]
  ds_read_b64_tr_b16 v[164:165], v11 offset:4096
  ds_read_b64_tr_b16 v[166:167], v11 offset:5120
  ds_read_b64_tr_b16 v[168:169], v12 offset:4096
  ds_read_b64_tr_b16 v[170:171], v12 offset:5120
  v_mfma_f32_16x16x32_bf16 v[180:183], v[132:135], v[48:51], v[180:183]
  s_add_u32 m0, s46, 0
  s_add_u32 s61, s50, 384
  buffer_load_dwordx4 v3, s[20:23], s61 offen lds
  v_or_b32 v231, 1, v231
  v_mfma_f32_16x16x32_bf16 v[188:191], v[132:135], v[52:55], v[188:191]
  s_add_u32 m0, s46, 8192
  s_add_u32 s61, s51, 512
  buffer_load_dwordx4 v3, s[20:23], s61 offen lds
  s_sub_u32 s68, s68, 1835008
  buffer_store_dwordx4 v[228:231], v5, s[16:19], s68 offen sc1
  v_mfma_f32_16x16x32_bf16 v[176:179], v[140:143], v[56:59], v[176:179]
  v_mfma_f32_16x16x32_bf16 v[184:187], v[140:143], v[60:63], v[184:187]
  v_mfma_f32_16x16x32_bf16 v[180:183], v[144:147], v[56:59], v[180:183]
  v_mfma_f32_16x16x32_bf16 v[188:191], v[144:147], v[60:63], v[188:191]
  s_mul_i32 s64, s47, -73728
  s_add_u32 s64, s64, 106496
  v_add_u32 v11, s64, v8
  v_add_u32 v12, s64, v9
  s_waitcnt lgkmcnt(0)
  s_barrier
  v_mfma_f32_16x16x32_bf16 v[176:179], v[152:155], v[64:67], v[176:179]
  ds_read_b64_tr_b16 v[128:129], v11 offset:0
  ds_read_b64_tr_b16 v[130:131], v11 offset:1024
  ds_read_b64_tr_b16 v[132:133], v12 offset:0
  ds_read_b64_tr_b16 v[134:135], v12 offset:1024
  v_mfma_f32_16x16x32_bf16 v[184:187], v[152:155], v[68:71], v[184:187]
  ds_read_b64_tr_b16 v[140:141], v11 offset:4096
  ds_read_b64_tr_b16 v[142:143], v11 offset:5120
  ds_read_b64_tr_b16 v[144:145], v12 offset:4096
  ds_read_b64_tr_b16 v[146:147], v12 offset:5120
  v_mfma_f32_16x16x32_bf16 v[180:183], v[156:159], v[64:67], v[180:183]
  s_add_u32 m0, s46, 147456
  s_add_u32 s61, s51, 640
  buffer_load_dwordx4 v3, s[20:23], s61 offen lds
  v_mfma_f32_16x16x32_bf16 v[188:191], v[156:159], v[68:71], v[188:191]
  s_add_u32 m0, s46, 98304
  s_add_u32 s61, s51, 768
  buffer_load_dwordx4 v3, s[20:23], s61 offen lds
  v_mfma_f32_16x16x32_bf16 v[176:179], v[164:167], v[72:75], v[176:179]
  v_mfma_f32_16x16x32_bf16 v[184:187], v[164:167], v[76:79], v[184:187]
  v_mfma_f32_16x16x32_bf16 v[180:183], v[168:171], v[72:75], v[180:183]
  v_mfma_f32_16x16x32_bf16 v[188:191], v[168:171], v[76:79], v[188:191]
  s_mul_i32 s64, s47, 73728
  s_add_u32 s64, s64, 40960
  v_add_u32 v11, s64, v8
  v_add_u32 v12, s64, v9
  s_waitcnt lgkmcnt(0)
  v_mfma_f32_16x16x32_bf16 v[176:179], v[128:131], v[80:83], v[176:179]
  ds_read_b64_tr_b16 v[152:153], v11 offset:0
  ds_read_b64_tr_b16 v[154:155], v11 offset:1024
  ds_read_b64_tr_b16 v[156:157], v12 offset:0
  ds_read_b64_tr_b16 v[158:159], v12 offset:1024
  v_mfma_f32_16x16x32_bf16 v[184:187], v[128:131], v[84:87], v[184:187]
  ds_read_b64_tr_b16 v[164:165], v11 offset:4096
  ds_read_b64_tr_b16 v[166:167], v11 offset:5120
  ds_read_b64_tr_b16 v[168:169], v12 offset:4096
  ds_read_b64_tr_b16 v[170:171], v12 offset:5120
  v_mfma_f32_16x16x32_bf16 v[180:183], v[132:135], v[80:83], v[180:183]
  s_add_u32 m0, s46, 16384
  s_add_u32 s61, s51, 896
  buffer_load_dwordx4 v3, s[20:23], s61 offen lds
  v_mfma_f32_16x16x32_bf16 v[188:191], v[132:135], v[84:87], v[188:191]
  s_add_u32 m0, s46, 24576
  s_add_u32 s61, s51, 1024
  buffer_load_dwordx4 v3, s[20:23], s61 offen lds
  v_mfma_f32_16x16x32_bf16 v[176:179], v[140:143], v[88:91], v[176:179]
  v_mfma_f32_16x16x32_bf16 v[184:187], v[140:143], v[92:95], v[184:187]
  v_mfma_f32_16x16x32_bf16 v[180:183], v[144:147], v[88:91], v[180:183]
  v_mfma_f32_16x16x32_bf16 v[188:191], v[144:147], v[92:95], v[188:191]
  s_mul_i32 s64, s47, 8192
  s_add_u32 s64, s64, 49152
  v_add_u32 v11, s64, v8
  v_add_u32 v12, s64, v9
  s_waitcnt vmcnt(17) lgkmcnt(0)
  s_waitcnt vmcnt(4)
  s_barrier
  s_cmp_lg_u32 s40, 2
  s_cbranch_scc1 OW_8
  s_lshl_b32 s64, s42, 5
  s_add_u32 s64, s64, s41
  s_lshl_b32 s64, s64, 7
  s_add_u32 s64, s64, 32768
  s_mov_b64 exec, 1
  v_mov_b32 v14, s43
  buffer_store_dword v14, off, s[16:19], s64 sc1
  s_mov_b64 exec, -1
  s_nop 4
OW_8:
  v_mfma_f32_16x16x32_bf16 v[176:179], v[152:155], v[96:99], v[176:179]
  ds_read_b64_tr_b16 v[128:129], v11 offset:0
  ds_read_b64_tr_b16 v[130:131], v11 offset:1024
  ds_read_b64_tr_b16 v[132:133], v12 offset:0
  ds_read_b64_tr_b16 v[134:135], v12 offset:1024
  v_mfma_f32_16x16x32_bf16 v[184:187], v[152:155], v[100:103], v[184:187]
  ds_read_b64_tr_b16 v[140:141], v11 offset:4096
  ds_read_b64_tr_b16 v[142:143], v11 offset:5120
  ds_read_b64_tr_b16 v[144:145], v12 offset:4096
  ds_read_b64_tr_b16 v[146:147], v12 offset:5120
  v_mfma_f32_16x16x32_bf16 v[180:183], v[156:159], v[96:99], v[180:183]
  s_add_u32 m0, s46, 106496
  s_add_u32 s61, s51, 1152
  buffer_load_dwordx4 v3, s[20:23], s61 offen lds
  v_mfma_f32_16x16x32_bf16 v[188:191], v[156:159], v[100:103], v[188:191]
  s_add_u32 m0, s46, 32768
  s_add_u32 s61, s51, 1280
  buffer_load_dwordx4 v3, s[20:23], s61 offen lds
  v_mfma_f32_16x16x32_bf16 v[176:179], v[164:167], v[104:107], v[176:179]
  s_add_u32 m0, s46, 40960
  s_add_u32 s61, s51, 1408
  buffer_load_dwordx4 v3, s[20:23], s61 offen lds
  v_mfma_f32_16x16x32_bf16 v[184:187], v[164:167], v[108:111], v[184:187]
  s_add_u32 m0, s46, 114688
  s_add_u32 s61, s51, 1536
  buffer_load_dwordx4 v3, s[20:23], s61 offen lds
  v_mfma_f32_16x16x32_bf16 v[180:183], v[168:171], v[104:107], v[180:183]
  v_mfma_f32_16x16x32_bf16 v[188:191], v[168:171], v[108:111], v[188:191]
  s_cmp_lg_u32 s40, 3
  s_cbranch_scc1 OW_9
  s_lshl_b32 s59, s74, 4
  v_add_u32 v244, s59, v0
  s_xor_b32 s59, s41, 8
  v_mov_b32 v245, s59
  v_cmp_lt_u32 vcc, 15, v0
  s_nop 1
  v_cndmask_b32 v244, v244, v245, vcc
  v_lshlrev_b32 v244, 7, v244
  s_lshl_b32 s59, s42, 12
  s_add_u32 s59, s59, 0
  buffer_load_dword v245, v244, s[16:19], s59 offen sc1
  s_nop 4
OW_9:
  s_waitcnt lgkmcnt(0)
  s_barrier
  v_mfma_f32_16x16x32_bf16 v[176:179], v[128:131], v[112:115], v[176:179]
  s_add_u32 m0, s46, 49152
  s_add_u32 s61, s51, 1664
  buffer_load_dwordx4 v3, s[20:23], s61 offen lds
  s_lshl_b32 s68, s45, 6
  v_mfma_f32_16x16x32_bf16 v[184:187], v[128:131], v[116:119], v[184:187]
  s_add_u32 m0, s46, 57344
  s_add_u32 s61, s51, 1792
  buffer_load_dwordx4 v3, s[20:23], s61 offen lds
  v_xor_b32 v246, s68, v6
  v_mfma_f32_16x16x32_bf16 v[180:183], v[132:135], v[112:115], v[180:183]
  v_subrev_u32 v246, 98304, v246
  v_mfma_f32_16x16x32_bf16 v[188:191], v[132:135], v[116:119], v[188:191]
  v_xor_b32 v247, 4096, v246
  v_mfma_f32_16x16x32_bf16 v[176:179], v[140:143], v[120:123], v[176:179]
  v_add_u32 v248, 57344, v246
  v_mfma_f32_16x16x32_bf16 v[184:187], v[140:143], v[124:127], v[184:187]
  v_add_u32 v249, 57344, v247
  v_mfma_f32_16x16x32_bf16 v[180:183], v[144:147], v[120:123], v[180:183]
  v_add_u32 v250, 114688, v246
  v_mfma_f32_16x16x32_bf16 v[188:191], v[144:147], v[124:127], v[188:191]
  v_add_u32 v251, 114688, v247
  s_cmp_lg_u32 s40, 3
  s_cbranch_scc1 OW_10
  s_waitcnt vmcnt(2)
  s_movk_i32 s62, 0x1000
  s_branch PC_13
PL_11:
  buffer_load_dword v245, v244, s[16:19], s59 offen sc1
  s_waitcnt vmcnt(0)
PC_13:
  v_cmp_ne_u32 vcc, s43, v245
  s_nop 1
  s_cbranch_vccz PD_12
  s_sleep 2
  s_sub_u32 s62, s62, 1
  s_cbranch_scc0 PL_11
PD_12:
  s_nop 4
OW_10:
  s_barrier
  s_add_u32 s60, s72, 0
  buffer_load_dwordx4 v[16:19], v5, s[16:19], s60 offen sc1
  buffer_load_dwordx4 v[20:23], v5, s[16:19], s60 offen offset:1024 sc1
  s_add_u32 s60, s72, 4096
  buffer_load_dwordx4 v[24:27], v5, s[16:19], s60 offen sc1
  buffer_load_dwordx4 v[28:31], v5, s[16:19], s60 offen offset:1024 sc1
  ds_read_b128 v[144:147], v250 offset:8192
  ds_read_b128 v[148:151], v250 offset:10240
  ds_read_b128 v[152:155], v251 offset:8192
  ds_read_b128 v[156:159], v251 offset:10240
  v_lshlrev_b32 v192, 16, v240
  v_lshlrev_b32 v193, 16, v240
  v_lshlrev_b32 v194, 16, v240
  v_lshlrev_b32 v195, 16, v240
  v_lshlrev_b32 v196, 16, v240
  v_lshlrev_b32 v197, 16, v240
  v_lshlrev_b32 v198, 16, v240
  v_lshlrev_b32 v199, 16, v240
  v_lshlrev_b32 v200, 16, v242
  v_lshlrev_b32 v201, 16, v242
  v_lshlrev_b32 v202, 16, v242
  v_lshlrev_b32 v203, 16, v242
  v_lshlrev_b32 v204, 16, v242
  v_lshlrev_b32 v205, 16, v242
  v_lshlrev_b32 v206, 16, v242
  v_lshlrev_b32 v207, 16, v242
  s_movk_i32 s60, 896
  v_lshrrev_b32 v12, 3, v0
  v_and_b32 v4, 6, v12
  v_xor_b32 v4, v4, v0
  v_and_b32 v4, 7, v4
  v_lshlrev_b32 v4, 4, v4
  v_mad_u32_u24 v1, v12, s60, v4
  s_mul_i32 s55, s40, 7168
  s_lshl_b32 s64, s71, 7
  s_add_u32 s55, s55, s64
  s_lshl_b32 s58, s70, 1
  s_add_u32 s58, s58, s47
  s_lshl_b32 s58, s58, 3
  s_and_b32 s65, s40, 1
  s_add_u32 s58, s58, s65
  s_mul_i32 s58, s58, 3584
  s_add_u32 s58, s58, s64
  s_lshl_b32 s64, s45, 6
  s_add_u32 s58, s58, s64
  s_lshl_b32 s54, s70, 2
  s_add_u32 s54, s54, s44
  s_lshr_b32 s57, s54, 1
  s_lshl_b32 s64, s45, 6
  s_add_u32 s57, s57, s64
  s_lshl_b32 s57, s57, 10
  s_mul_i32 s64, s65, 1835008
  s_add_u32 s57, s57, s64
  s_add_u32 s57, s57, 4718592
  s_mul_i32 s54, s54, 14336
  s_lshl_b32 s64, s45, 10
  s_add_u32 s54, s54, s64
  s_add_u32 s54, s54, 8388608
  s_lshl_b32 s64, s45, 11
  s_xor_b32 s75, s64, s46
  s_lshl_b32 s92, s53, 6
  s_add_u32 s92, s92, s52
  s_lshl_b32 s92, s92, 10
  s_add_u32 s92, s92, 4718592
  s_add_u32 s93, s92, 1835008
  v_add_u32 v6, s75, v5
  v_xor_b32 v7, 6144, v6
  s_waitcnt vmcnt(2) lgkmcnt(3)
  v_mfma_f32_16x16x32_bf16 v[80:83], v[16:19], v[144:147], 0
  ds_read_b128 v[160:163], v248 offset:8192
  ds_read_b128 v[164:167], v248 offset:10240
  ds_read_b128 v[168:171], v249 offset:8192
  v_mfma_f32_16x16x32_bf16 v[84:87], v[20:23], v[144:147], 0
  ds_read_b128 v[172:175], v249 offset:10240
  v_mul_f32 v224, v176, v176
  v_mul_f32 v225, v177, v177
  s_waitcnt lgkmcnt(6)
  v_mfma_f32_16x16x32_bf16 v[88:91], v[16:19], v[148:151], 0
  v_mul_f32 v226, v178, v178
  v_mul_f32 v227, v179, v179
  v_mfma_f32_16x16x32_bf16 v[92:95], v[20:23], v[148:151], 0
  v_mul_f32 v228, v180, v180
  v_mul_f32 v229, v181, v181
  s_waitcnt lgkmcnt(5)
  v_mfma_f32_16x16x32_bf16 v[96:99], v[16:19], v[152:155], 0
  v_mul_f32 v230, v182, v182
  v_mul_f32 v231, v183, v183
  v_mfma_f32_16x16x32_bf16 v[100:103], v[20:23], v[152:155], 0
  v_mul_f32 v232, v184, v184
  v_mul_f32 v233, v185, v185
  s_waitcnt lgkmcnt(4)
  v_mfma_f32_16x16x32_bf16 v[104:107], v[16:19], v[156:159], 0
  v_mul_f32 v234, v186, v186
  v_mul_f32 v235, v187, v187
  v_mfma_f32_16x16x32_bf16 v[108:111], v[20:23], v[156:159], 0
  s_add_u32 s60, s72, 8192
  buffer_load_dwordx4 v[32:35], v5, s[16:19], s60 offen sc1
  buffer_load_dwordx4 v[36:39], v5, s[16:19], s60 offen offset:1024 sc1
  s_waitcnt lgkmcnt(3)
  v_mfma_f32_16x16x32_bf16 v[192:195], v[16:19], v[160:163], v[192:195]
  ds_read_b128 v[144:147], v248 offset:16384
  ds_read_b128 v[148:151], v248 offset:18432
  ds_read_b128 v[152:155], v249 offset:16384
  v_mfma_f32_16x16x32_bf16 v[196:199], v[20:23], v[160:163], v[196:199]
  ds_read_b128 v[156:159], v249 offset:18432
  v_mul_f32 v236, v188, v188
  v_mul_f32 v237, v189, v189
  s_waitcnt lgkmcnt(6)
  v_mfma_f32_16x16x32_bf16 v[200:203], v[16:19], v[164:167], v[200:203]
  v_mul_f32 v238, v190, v190
  v_mul_f32 v239, v191, v191
  v_mfma_f32_16x16x32_bf16 v[204:207], v[20:23], v[164:167], v[204:207]
  v_fma_f32 v224, v224, v254, v252
  v_fma_f32 v225, v225, v254, v252
  s_waitcnt lgkmcnt(5)
  v_mfma_f32_16x16x32_bf16 v[208:211], v[16:19], v[168:171], 0
  v_fma_f32 v226, v226, v254, v252
  v_fma_f32 v227, v227, v254, v252
  v_mfma_f32_16x16x32_bf16 v[212:215], v[20:23], v[168:171], 0
  v_fma_f32 v228, v228, v254, v252
  v_fma_f32 v229, v229, v254, v252
  s_waitcnt lgkmcnt(4)
  v_mfma_f32_16x16x32_bf16 v[216:219], v[16:19], v[172:175], 0
  v_fma_f32 v230, v230, v254, v252
  v_fma_f32 v231, v231, v254, v252
  v_mfma_f32_16x16x32_bf16 v[220:223], v[20:23], v[172:175], 0
  s_add_u32 s60, s72, 12288
  buffer_load_dwordx4 v[40:43], v5, s[16:19], s60 offen sc1
  buffer_load_dwordx4 v[44:47], v5, s[16:19], s60 offen offset:1024 sc1
  s_waitcnt vmcnt(4) lgkmcnt(3)
  v_mfma_f32_16x16x32_bf16 v[80:83], v[24:27], v[144:147], v[80:83]
  ds_read_b128 v[160:163], v250 offset:16384
  ds_read_b128 v[164:167], v250 offset:18432
  ds_read_b128 v[168:171], v251 offset:16384
  v_mfma_f32_16x16x32_bf16 v[84:87], v[28:31], v[144:147], v[84:87]
  ds_read_b128 v[172:175], v251 offset:18432
  v_fma_f32 v232, v232, v254, v252
  s_waitcnt lgkmcnt(6)
  v_mfma_f32_16x16x32_bf16 v[88:91], v[24:27], v[148:151], v[88:91]
  v_fma_f32 v233, v233, v254, v252
  v_fma_f32 v234, v234, v254, v252
  v_mfma_f32_16x16x32_bf16 v[92:95], v[28:31], v[148:151], v[92:95]
  v_fma_f32 v235, v235, v254, v252
  v_fma_f32 v236, v236, v254, v252
  s_waitcnt lgkmcnt(5)
  v_mfma_f32_16x16x32_bf16 v[96:99], v[24:27], v[152:155], v[96:99]
  v_fma_f32 v237, v237, v254, v252
  v_fma_f32 v238, v238, v254, v252
  v_mfma_f32_16x16x32_bf16 v[100:103], v[28:31], v[152:155], v[100:103]
  v_fma_f32 v239, v239, v254, v252
  v_mul_f32 v224, v224, v176
  s_waitcnt lgkmcnt(4)
  v_mfma_f32_16x16x32_bf16 v[104:107], v[24:27], v[156:159], v[104:107]
  v_mul_f32 v225, v225, v177
  v_mul_f32 v226, v226, v178
  v_mfma_f32_16x16x32_bf16 v[108:111], v[28:31], v[156:159], v[108:111]
  s_add_u32 s60, s72, 16384
  buffer_load_dwordx4 v[112:115], v5, s[16:19], s60 offen sc1
  buffer_load_dwordx4 v[116:119], v5, s[16:19], s60 offen offset:1024 sc1
  s_waitcnt lgkmcnt(3)
  v_mfma_f32_16x16x32_bf16 v[192:195], v[24:27], v[160:163], v[192:195]
  ds_read_b128 v[144:147], v248 offset:24576
  ds_read_b128 v[148:151], v248 offset:26624
  ds_read_b128 v[152:155], v249 offset:24576
  v_mfma_f32_16x16x32_bf16 v[196:199], v[28:31], v[160:163], v[196:199]
  ds_read_b128 v[156:159], v249 offset:26624
  v_mul_f32 v227, v227, v179
  s_waitcnt lgkmcnt(6)
  v_mfma_f32_16x16x32_bf16 v[200:203], v[24:27], v[164:167], v[200:203]
  v_mul_f32 v228, v228, v180
  v_mul_f32 v229, v229, v181
  v_mfma_f32_16x16x32_bf16 v[204:207], v[28:31], v[164:167], v[204:207]
  v_mul_f32 v230, v230, v182
  v_mul_f32 v231, v231, v183
  s_waitcnt lgkmcnt(5)
  v_mfma_f32_16x16x32_bf16 v[208:211], v[24:27], v[168:171], v[208:211]
  v_mul_f32 v232, v232, v184
  v_mul_f32 v233, v233, v185
  v_mfma_f32_16x16x32_bf16 v[212:215], v[28:31], v[168:171], v[212:215]
  v_mul_f32 v234, v234, v186
  v_mul_f32 v235, v235, v187
  s_waitcnt lgkmcnt(4)
  v_mfma_f32_16x16x32_bf16 v[216:219], v[24:27], v[172:175], v[216:219]
  v_mul_f32 v236, v236, v188
  v_mul_f32 v237, v237, v189
  v_mfma_f32_16x16x32_bf16 v[220:223], v[28:31], v[172:175], v[220:223]
  s_add_u32 s60, s72, 20480
  buffer_load_dwordx4 v[120:123], v5, s[16:19], s60 offen sc1
  buffer_load_dwordx4 v[124:127], v5, s[16:19], s60 offen offset:1024 sc1
  s_waitcnt vmcnt(6) lgkmcnt(0)
  s_barrier
  v_mfma_f32_16x16x32_bf16 v[80:83], v[32:35], v[144:147], v[80:83]
  ds_read_b128 v[160:163], v248 offset:32768
  ds_read_b128 v[164:167], v248 offset:34816
  ds_read_b128 v[168:171], v249 offset:32768
  v_mfma_f32_16x16x32_bf16 v[84:87], v[36:39], v[144:147], v[84:87]
  ds_read_b128 v[172:175], v249 offset:34816
  v_mul_f32 v238, v238, v190
  v_mfma_f32_16x16x32_bf16 v[88:91], v[32:35], v[148:151], v[88:91]
  v_mul_f32 v239, v239, v191
  v_exp_f32 v224, v224
  v_mfma_f32_16x16x32_bf16 v[92:95], v[36:39], v[148:151], v[92:95]
  v_exp_f32 v225, v225
  v_exp_f32 v226, v226
  v_mfma_f32_16x16x32_bf16 v[96:99], v[32:35], v[152:155], v[96:99]
  v_exp_f32 v227, v227
  v_exp_f32 v228, v228
  v_exp_f32 v229, v229
  v_mfma_f32_16x16x32_bf16 v[100:103], v[36:39], v[152:155], v[100:103]
  v_exp_f32 v230, v230
  v_exp_f32 v231, v231
  v_mfma_f32_16x16x32_bf16 v[104:107], v[32:35], v[156:159], v[104:107]
  v_exp_f32 v232, v232
  s_add_u32 s60, s72, 24576
  buffer_load_dwordx4 v[128:131], v5, s[16:19], s60 offen sc1
  v_mfma_f32_16x16x32_bf16 v[108:111], v[36:39], v[156:159], v[108:111]
  buffer_load_dwordx4 v[132:135], v5, s[16:19], s60 offen offset:1024 sc1
  s_add_u32 m0, s46, 122880
  s_add_u32 s61, s51, 1920
  buffer_load_dwordx4 v3, s[20:23], s61 offen lds
  s_waitcnt lgkmcnt(3)
  v_mfma_f32_16x16x32_bf16 v[192:195], v[32:35], v[160:163], v[192:195]
  ds_read_b128 v[144:147], v250 offset:24576
  ds_read_b128 v[148:151], v250 offset:26624
  ds_read_b128 v[152:155], v251 offset:24576
  v_mfma_f32_16x16x32_bf16 v[196:199], v[36:39], v[160:163], v[196:199]
  ds_read_b128 v[156:159], v251 offset:26624
  v_exp_f32 v233, v233
  s_waitcnt lgkmcnt(6)
  v_mfma_f32_16x16x32_bf16 v[200:203], v[32:35], v[164:167], v[200:203]
  v_exp_f32 v234, v234
  v_exp_f32 v235, v235
  v_mfma_f32_16x16x32_bf16 v[204:207], v[36:39], v[164:167], v[204:207]
  v_exp_f32 v236, v236
  v_exp_f32 v237, v237
  s_waitcnt lgkmcnt(5)
  v_mfma_f32_16x16x32_bf16 v[208:211], v[32:35], v[168:171], v[208:211]
  v_exp_f32 v238, v238
  v_exp_f32 v239, v239
  v_add_f32 v224, 1.0, v224
  v_mfma_f32_16x16x32_bf16 v[212:215], v[36:39], v[168:171], v[212:215]
  v_add_f32 v225, 1.0, v225
  v_add_f32 v226, 1.0, v226
  s_waitcnt lgkmcnt(4)
  v_mfma_f32_16x16x32_bf16 v[216:219], v[32:35], v[172:175], v[216:219]
  v_add_f32 v227, 1.0, v227
  s_add_u32 s60, s72, 28672
  buffer_load_dwordx4 v[136:139], v5, s[16:19], s60 offen sc1
  v_mfma_f32_16x16x32_bf16 v[220:223], v[36:39], v[172:175], v[220:223]
  buffer_load_dwordx4 v[140:143], v5, s[16:19], s60 offen offset:1024 sc1
  s_add_u32 m0, s46, 65536
  s_add_u32 s61, s50, 512
  buffer_load_dwordx4 v3, s[20:23], s61 offen lds
  s_waitcnt vmcnt(10) lgkmcnt(3)
  v_mfma_f32_16x16x32_bf16 v[80:83], v[40:43], v[144:147], v[80:83]
  ds_read_b128 v[160:163], v246 offset:0
  ds_read_b128 v[164:167], v246 offset:2048
  ds_read_b128 v[168:171], v247 offset:0
  v_mfma_f32_16x16x32_bf16 v[84:87], v[44:47], v[144:147], v[84:87]
  ds_read_b128 v[172:175], v247 offset:2048
  v_add_f32 v228, 1.0, v228
  s_waitcnt lgkmcnt(6)
  v_mfma_f32_16x16x32_bf16 v[88:91], v[40:43], v[148:151], v[88:91]
  v_add_f32 v229, 1.0, v229
  v_add_f32 v230, 1.0, v230
  v_mfma_f32_16x16x32_bf16 v[92:95], v[44:47], v[148:151], v[92:95]
  v_add_f32 v231, 1.0, v231
  v_add_f32 v232, 1.0, v232
  s_waitcnt lgkmcnt(5)
  v_mfma_f32_16x16x32_bf16 v[96:99], v[40:43], v[152:155], v[96:99]
  v_add_f32 v233, 1.0, v233
  v_add_f32 v234, 1.0, v234
  v_add_f32 v235, 1.0, v235
  v_mfma_f32_16x16x32_bf16 v[100:103], v[44:47], v[152:155], v[100:103]
  v_add_f32 v236, 1.0, v236
  v_add_f32 v237, 1.0, v237
  s_waitcnt lgkmcnt(4)
  v_mfma_f32_16x16x32_bf16 v[104:107], v[40:43], v[156:159], v[104:107]
  v_add_f32 v238, 1.0, v238
  s_add_u32 s60, s72, 32768
  buffer_load_dwordx4 v[48:51], v5, s[16:19], s60 offen sc1
  v_mfma_f32_16x16x32_bf16 v[108:111], v[44:47], v[156:159], v[108:111]
  buffer_load_dwordx4 v[52:55], v5, s[16:19], s60 offen offset:1024 sc1
  s_add_u32 m0, s46, 73728
  s_add_u32 s61, s50, 640
  buffer_load_dwordx4 v3, s[20:23], s61 offen lds
  s_waitcnt lgkmcnt(3)
  v_mfma_f32_16x16x32_bf16 v[192:195], v[40:43], v[160:163], v[192:195]
  ds_read_b128 v[144:147], v246 offset:8192
  ds_read_b128 v[148:151], v246 offset:10240
  ds_read_b128 v[152:155], v247 offset:8192
  v_mfma_f32_16x16x32_bf16 v[196:199], v[44:47], v[160:163], v[196:199]
  ds_read_b128 v[156:159], v247 offset:10240
  v_add_f32 v239, 1.0, v239
  s_waitcnt lgkmcnt(6)
  v_mfma_f32_16x16x32_bf16 v[200:203], v[40:43], v[164:167], v[200:203]
  v_rcp_f32 v224, v224
  v_rcp_f32 v225, v225
  v_mfma_f32_16x16x32_bf16 v[204:207], v[44:47], v[164:167], v[204:207]
  v_rcp_f32 v226, v226
  v_rcp_f32 v227, v227
  s_waitcnt lgkmcnt(5)
  v_mfma_f32_16x16x32_bf16 v[208:211], v[40:43], v[168:171], v[208:211]
  v_rcp_f32 v228, v228
  v_rcp_f32 v229, v229
  v_rcp_f32 v230, v230
  v_mfma_f32_16x16x32_bf16 v[212:215], v[44:47], v[168:171], v[212:215]
  v_rcp_f32 v231, v231
  v_rcp_f32 v232, v232
  s_waitcnt lgkmcnt(4)
  v_mfma_f32_16x16x32_bf16 v[216:219], v[40:43], v[172:175], v[216:219]
  v_rcp_f32 v233, v233
  s_add_u32 s60, s72, 36864
  buffer_load_dwordx4 v[56:59], v5, s[16:19], s60 offen sc1
  v_mfma_f32_16x16x32_bf16 v[220:223], v[44:47], v[172:175], v[220:223]
  buffer_load_dwordx4 v[60:63], v5, s[16:19], s60 offen offset:1024 sc1
  s_add_u32 m0, s46, 131072
  s_add_u32 s61, s50, 768
  buffer_load_dwordx4 v3, s[20:23], s61 offen lds
  s_waitcnt vmcnt(14) lgkmcnt(0)
  s_barrier
  v_mfma_f32_16x16x32_bf16 v[80:83], v[112:115], v[144:147], v[80:83]
  ds_read_b128 v[160:163], v250 offset:32768
  ds_read_b128 v[164:167], v250 offset:34816
  ds_read_b128 v[168:171], v251 offset:32768
  v_mfma_f32_16x16x32_bf16 v[84:87], v[116:119], v[144:147], v[84:87]
  ds_read_b128 v[172:175], v251 offset:34816
  v_rcp_f32 v234, v234
  v_mfma_f32_16x16x32_bf16 v[88:91], v[112:115], v[148:151], v[88:91]
  v_rcp_f32 v235, v235
  v_rcp_f32 v236, v236
  v_mfma_f32_16x16x32_bf16 v[92:95], v[116:119], v[148:151], v[92:95]
  v_rcp_f32 v237, v237
  v_rcp_f32 v238, v238
  v_mfma_f32_16x16x32_bf16 v[96:99], v[112:115], v[152:155], v[96:99]
  v_rcp_f32 v239, v239
  v_mul_f32 v176, v176, v224
  v_mul_f32 v177, v177, v225
  v_mfma_f32_16x16x32_bf16 v[100:103], v[116:119], v[152:155], v[100:103]
  v_mul_f32 v178, v178, v226
  v_mul_f32 v179, v179, v227
  v_mfma_f32_16x16x32_bf16 v[104:107], v[112:115], v[156:159], v[104:107]
  v_mul_f32 v180, v180, v228
  s_add_u32 s60, s72, 40960
  buffer_load_dwordx4 v[64:67], v5, s[16:19], s60 offen sc1
  v_mfma_f32_16x16x32_bf16 v[108:111], v[116:119], v[156:159], v[108:111]
  buffer_load_dwordx4 v[68:71], v5, s[16:19], s60 offen offset:1024 sc1
  s_add_u32 m0, s46, 81920
  s_add_u32 s61, s50, 896
  buffer_load_dwordx4 v3, s[20:23], s61 offen lds
  s_waitcnt vmcnt(15) lgkmcnt(3)
  v_mfma_f32_16x16x32_bf16 v[80:83], v[120:123], v[160:163], v[80:83]
  ds_read_b128 v[144:147], v248 offset:40960
  ds_read_b128 v[148:151], v248 offset:43008
  ds_read_b128 v[152:155], v249 offset:40960
  v_mfma_f32_16x16x32_bf16 v[84:87], v[124:127], v[160:163], v[84:87]
  ds_read_b128 v[156:159], v249 offset:43008
  v_mul_f32 v181, v181, v229
  s_waitcnt lgkmcnt(6)
  v_mfma_f32_16x16x32_bf16 v[88:91], v[120:123], v[164:167], v[88:91]
  v_mul_f32 v182, v182, v230
  v_mul_f32 v183, v183, v231
  v_mfma_f32_16x16x32_bf16 v[92:95], v[124:127], v[164:167], v[92:95]
  v_mul_f32 v184, v184, v232
  v_mul_f32 v185, v185, v233
  s_waitcnt lgkmcnt(5)
  v_mfma_f32_16x16x32_bf16 v[96:99], v[120:123], v[168:171], v[96:99]
  v_mul_f32 v186, v186, v234
  v_mul_f32 v187, v187, v235
  v_mul_f32 v188, v188, v236
  v_mfma_f32_16x16x32_bf16 v[100:103], v[124:127], v[168:171], v[100:103]
  v_mul_f32 v189, v189, v237
  v_mul_f32 v190, v190, v238
  s_waitcnt lgkmcnt(4)
  v_mfma_f32_16x16x32_bf16 v[104:107], v[120:123], v[172:175], v[104:107]
  v_mul_f32 v191, v191, v239
  s_add_u32 s60, s72, 45056
  buffer_load_dwordx4 v[72:75], v5, s[16:19], s60 offen sc1
  v_mfma_f32_16x16x32_bf16 v[108:111], v[124:127], v[172:175], v[108:111]
  buffer_load_dwordx4 v[76:79], v5, s[16:19], s60 offen offset:1024 sc1
  s_add_u32 m0, s46, 90112
  s_add_u32 s61, s50, 1024
  buffer_load_dwordx4 v3, s[20:23], s61 offen lds
  s_waitcnt vmcnt(16) lgkmcnt(3)
  v_mfma_f32_16x16x32_bf16 v[80:83], v[128:131], v[144:147], v[80:83]
  ds_read_b128 v[160:163], v246 offset:16384
  ds_read_b128 v[164:167], v246 offset:18432
  v_mfma_f32_16x16x32_bf16 v[84:87], v[132:135], v[144:147], v[84:87]
  ds_read_b128 v[168:171], v247 offset:16384
  ds_read_b128 v[172:175], v247 offset:18432
  s_waitcnt lgkmcnt(6)
  v_mfma_f32_16x16x32_bf16 v[88:91], v[128:131], v[148:151], v[88:91]
  v_and_b32 v224, 1, v0
  v_lshlrev_b32 v224, 4, v224
  v_mfma_f32_16x16x32_bf16 v[92:95], v[132:135], v[148:151], v[92:95]
  s_movk_i32 s64, 0x3f80
  v_lshlrev_b32_e64 v224, v224, s64
  s_mov_b32 s64, 0x00300003
  s_mov_b32 s65, 0x30000300
  v_cndmask_b32_e64 v226, 0, v224, s[64:65]
  s_waitcnt lgkmcnt(5)
  v_mfma_f32_16x16x32_bf16 v[96:99], v[128:131], v[152:155], v[96:99]
  s_mov_b32 s64, 0x00c0000c
  s_mov_b32 s65, 0xc0000c00
  v_cndmask_b32_e64 v227, 0, v224, s[64:65]
  v_mov_b32 v224, 0
  v_mfma_f32_16x16x32_bf16 v[100:103], v[132:135], v[152:155], v[100:103]
  v_mov_b32 v225, 0
  v_mov_b32 v228, 0
  s_waitcnt lgkmcnt(4)
  v_mfma_f32_16x16x32_bf16 v[104:107], v[128:131], v[156:159], v[104:107]
  v_mov_b32 v229, 0
  s_add_u32 s60, s72, 49152
  buffer_load_dwordx4 v[16:19], v5, s[16:19], s60 offen sc1
  v_mfma_f32_16x16x32_bf16 v[108:111], v[132:135], v[156:159], v[108:111]
  buffer_load_dwordx4 v[20:23], v5, s[16:19], s60 offen offset:1024 sc1
  s_add_u32 m0, s46, 139264
  s_add_u32 s61, s50, 1152
  buffer_load_dwordx4 v3, s[20:23], s61 offen lds
  s_waitcnt vmcnt(16) lgkmcnt(3)
  v_mfma_f32_16x16x32_bf16 v[80:83], v[136:139], v[160:163], v[80:83]
  ds_read_b128 v[144:147], v246 offset:24576
  v_mfma_f32_16x16x32_bf16 v[84:87], v[140:143], v[160:163], v[84:87]
  ds_read_b128 v[148:151], v246 offset:26624
  s_waitcnt lgkmcnt(4)
  v_mfma_f32_16x16x32_bf16 v[88:91], v[136:139], v[164:167], v[88:91]
  ds_read_b128 v[152:155], v247 offset:24576
  v_mfma_f32_16x16x32_bf16 v[92:95], v[140:143], v[164:167], v[92:95]
  ds_read_b128 v[156:159], v247 offset:26624
  s_waitcnt lgkmcnt(5)
  v_mfma_f32_16x16x32_bf16 v[96:99], v[136:139], v[168:171], v[96:99]
  s_add_u32 s60, s72, 53248
  buffer_load_dwordx4 v[24:27], v5, s[16:19], s60 offen sc1
  v_mfma_f32_16x16x32_bf16 v[100:103], v[140:143], v[168:171], v[100:103]
  buffer_load_dwordx4 v[28:31], v5, s[16:19], s60 offen offset:1024 sc1
  s_waitcnt lgkmcnt(4)
  v_mfma_f32_16x16x32_bf16 v[104:107], v[136:139], v[172:175], v[104:107]
  s_add_u32 m0, s46, 0
  s_add_u32 s61, s50, 1280
  buffer_load_dwordx4 v3, s[20:23], s61 offen lds
  v_mfma_f32_16x16x32_bf16 v[108:111], v[140:143], v[172:175], v[108:111]
  s_waitcnt vmcnt(16) lgkmcnt(0)
  s_barrier
  v_mfma_f32_16x16x32_bf16 v[80:83], v[48:51], v[144:147], v[80:83]
  ds_read_b128 v[160:163], v248 offset:49152
  v_mfma_f32_16x16x32_bf16 v[84:87], v[52:55], v[144:147], v[84:87]
  ds_read_b128 v[164:167], v248 offset:51200
  v_mfma_f32_16x16x32_bf16 v[88:91], v[48:51], v[148:151], v[88:91]
  ds_read_b128 v[168:171], v249 offset:49152
  v_mfma_f32_16x16x32_bf16 v[92:95], v[52:55], v[148:151], v[92:95]
  ds_read_b128 v[172:175], v249 offset:51200
  v_mfma_f32_16x16x32_bf16 v[96:99], v[48:51], v[152:155], v[96:99]
  s_add_u32 s60, s72, 57344
  buffer_load_dwordx4 v[32:35], v5, s[16:19], s60 offen sc1
  v_mfma_f32_16x16x32_bf16 v[100:103], v[52:55], v[152:155], v[100:103]
  buffer_load_dwordx4 v[36:39], v5, s[16:19], s60 offen offset:1024 sc1
  v_mfma_f32_16x16x32_bf16 v[104:107], v[48:51], v[156:159], v[104:107]
  s_add_u32 m0, s46, 8192
  s_add_u32 s61, s50, 1408
  buffer_load_dwordx4 v3, s[20:23], s61 offen lds
  v_mfma_f32_16x16x32_bf16 v[108:111], v[52:55], v[156:159], v[108:111]
  s_waitcnt vmcnt(16) lgkmcnt(3)
  v_mfma_f32_16x16x32_bf16 v[80:83], v[56:59], v[160:163], v[80:83]
  ds_read_b128 v[144:147], v246 offset:32768
  v_mfma_f32_16x16x32_bf16 v[84:87], v[60:63], v[160:163], v[84:87]
  ds_read_b128 v[148:151], v246 offset:34816
  s_waitcnt lgkmcnt(4)
  v_mfma_f32_16x16x32_bf16 v[88:91], v[56:59], v[164:167], v[88:91]
  ds_read_b128 v[152:155], v247 offset:32768
  v_mfma_f32_16x16x32_bf16 v[92:95], v[60:63], v[164:167], v[92:95]
  ds_read_b128 v[156:159], v247 offset:34816
  s_waitcnt lgkmcnt(5)
  v_mfma_f32_16x16x32_bf16 v[96:99], v[56:59], v[168:171], v[96:99]
  s_add_u32 s60, s72, 61440
  buffer_load_dwordx4 v[40:43], v5, s[16:19], s60 offen sc1
  v_mfma_f32_16x16x32_bf16 v[100:103], v[60:63], v[168:171], v[100:103]
  buffer_load_dwordx4 v[44:47], v5, s[16:19], s60 offen offset:1024 sc1
  s_waitcnt lgkmcnt(4)
  v_mfma_f32_16x16x32_bf16 v[104:107], v[56:59], v[172:175], v[104:107]
  s_add_u32 m0, s46, 147456
  s_add_u32 s61, s50, 1536
  buffer_load_dwordx4 v3, s[20:23], s61 offen lds
  v_mfma_f32_16x16x32_bf16 v[108:111], v[60:63], v[172:175], v[108:111]
  s_waitcnt vmcnt(16) lgkmcnt(3)
  v_mfma_f32_16x16x32_bf16 v[80:83], v[64:67], v[144:147], v[80:83]
  ds_read_b128 v[160:163], v246 offset:40960
  v_mfma_f32_16x16x32_bf16 v[84:87], v[68:71], v[144:147], v[84:87]
  ds_read_b128 v[164:167], v246 offset:43008
  s_waitcnt lgkmcnt(4)
  v_mfma_f32_16x16x32_bf16 v[88:91], v[64:67], v[148:151], v[88:91]
  ds_read_b128 v[168:171], v247 offset:40960
  v_mfma_f32_16x16x32_bf16 v[92:95], v[68:71], v[148:151], v[92:95]
  ds_read_b128 v[172:175], v247 offset:43008
  s_waitcnt lgkmcnt(5)
  v_mfma_f32_16x16x32_bf16 v[96:99], v[64:67], v[152:155], v[96:99]
  s_add_u32 m0, s46, 98304
  s_add_u32 s61, s50, 1664
  buffer_load_dwordx4 v3, s[20:23], s61 offen lds
  v_mfma_f32_16x16x32_bf16 v[100:103], v[68:71], v[152:155], v[100:103]
  s_add_u32 m0, s46, 16384
  s_add_u32 s61, s50, 1792
  buffer_load_dwordx4 v3, s[20:23], s61 offen lds
  s_waitcnt lgkmcnt(4)
  v_mfma_f32_16x16x32_bf16 v[104:107], v[64:67], v[156:159], v[104:107]
  v_mfma_f32_16x16x32_bf16 v[108:111], v[68:71], v[156:159], v[108:111]
  s_waitcnt vmcnt(15) lgkmcnt(3)
  v_mfma_f32_16x16x32_bf16 v[80:83], v[72:75], v[160:163], v[80:83]
  ds_read_b128 v[144:147], v250 offset:0
  v_mfma_f32_16x16x32_bf16 v[84:87], v[76:79], v[160:163], v[84:87]
  ds_read_b128 v[148:151], v250 offset:2048
  s_waitcnt lgkmcnt(4)
  v_mfma_f32_16x16x32_bf16 v[88:91], v[72:75], v[164:167], v[88:91]
  ds_read_b128 v[152:155], v251 offset:0
  v_mfma_f32_16x16x32_bf16 v[92:95], v[76:79], v[164:167], v[92:95]
  ds_read_b128 v[156:159], v251 offset:2048
  s_waitcnt lgkmcnt(5)
  v_mfma_f32_16x16x32_bf16 v[96:99], v[72:75], v[168:171], v[96:99]
  s_add_u32 m0, s46, 24576
  s_add_u32 s61, s50, 1920
  buffer_load_dwordx4 v3, s[20:23], s61 offen lds
  v_mfma_f32_16x16x32_bf16 v[100:103], v[76:79], v[168:171], v[100:103]
  s_waitcnt lgkmcnt(4)
  v_mfma_f32_16x16x32_bf16 v[104:107], v[72:75], v[172:175], v[104:107]
  v_mfma_f32_16x16x32_bf16 v[108:111], v[76:79], v[172:175], v[108:111]
  s_waitcnt vmcnt(13) lgkmcnt(0)
  s_barrier
  v_mfma_f32_16x16x32_bf16 v[80:83], v[16:19], v[144:147], v[80:83]
  ds_read_b128 v[160:163], v246 offset:49152
  ds_read_b128 v[164:167], v246 offset:51200
  ds_read_b128 v[168:171], v247 offset:49152
  v_mfma_f32_16x16x32_bf16 v[84:87], v[20:23], v[144:147], v[84:87]
  ds_read_b128 v[172:175], v247 offset:51200
  v_bfe_u32 v3, v0, 2, 2
  v_lshlrev_b32 v3, 3, v3
  v_mfma_f32_16x16x32_bf16 v[88:91], v[16:19], v[148:151], v[88:91]
  v_and_b32 v13, 3, v0
  v_add_u32 v3, v3, v13
  v_mul_u32_u24 v3, 896, v3
  v_mfma_f32_16x16x32_bf16 v[92:95], v[20:23], v[148:151], v[92:95]
  v_bfe_u32 v13, v0, 4, 1
  v_lshl_add_u32 v3, v13, 5, v3
  v_lshrrev_b32 v13, 5, v0
  v_mfma_f32_16x16x32_bf16 v[96:99], v[16:19], v[152:155], v[96:99]
  v_lshl_add_u32 v3, v13, 4, v3
  v_lshlrev_b32 v2, 4, v13
  v_bfe_u32 v13, v0, 4, 1
  v_mfma_f32_16x16x32_bf16 v[100:103], v[20:23], v[152:155], v[100:103]
  v_lshl_add_u32 v2, v13, 5, v2
  v_bfe_u32 v13, v0, 2, 2
  v_lshl_add_u32 v2, v13, 10, v2
  v_mfma_f32_16x16x32_bf16 v[104:107], v[16:19], v[156:159], v[104:107]
  v_and_b32 v13, 3, v0
  v_lshl_add_u32 v2, v13, 7, v2
  v_mfma_f32_16x16x32_bf16 v[108:111], v[20:23], v[156:159], v[108:111]
  s_lshl_b32 s64, s47, 12
  s_and_b32 s65, s40, 1
  s_lshl_b32 s65, s65, 9
  s_add_u32 s64, s64, s65
  s_lshl_b32 s65, s45, 6
  s_add_u32 s64, s64, s65
  s_add_u32 s64, s64, 155648
  v_add_u32 v2, s64, v2
  s_add_u32 m0, s46, 40960
  s_add_u32 s61, s55, 0
  buffer_load_dwordx4 v1, s[32:35], s61 offen lds
  s_waitcnt vmcnt(11) lgkmcnt(3)
  v_mfma_f32_16x16x32_bf16 v[80:83], v[24:27], v[160:163], v[80:83]
  ds_read_b128 v[144:147], v248 offset:0
  ds_read_b128 v[148:151], v248 offset:2048
  v_mfma_f32_16x16x32_bf16 v[84:87], v[28:31], v[160:163], v[84:87]
  ds_read_b128 v[152:155], v249 offset:0
  ds_read_b128 v[156:159], v249 offset:2048
  s_waitcnt lgkmcnt(6)
  v_mfma_f32_16x16x32_bf16 v[88:91], v[24:27], v[164:167], v[88:91]
  v_add_u32 v8, 106496, v6
  v_mfma_f32_16x16x32_bf16 v[92:95], v[28:31], v[164:167], v[92:95]
  v_add_u32 v9, 32768, v6
  s_waitcnt lgkmcnt(5)
  v_mfma_f32_16x16x32_bf16 v[96:99], v[24:27], v[168:171], v[96:99]
  v_add_u32 v10, 106496, v7
  v_mfma_f32_16x16x32_bf16 v[100:103], v[28:31], v[168:171], v[100:103]
  v_add_u32 v11, 32768, v7
  s_waitcnt lgkmcnt(4)
  v_mfma_f32_16x16x32_bf16 v[104:107], v[24:27], v[172:175], v[104:107]
  s_add_u32 m0, s46, 114688
  s_add_u32 s61, s55, 57344
  buffer_load_dwordx4 v1, s[32:35], s61 offen lds
  v_mfma_f32_16x16x32_bf16 v[108:111], v[28:31], v[172:175], v[108:111]
  s_waitcnt vmcnt(9) lgkmcnt(3)
  v_mfma_f32_16x16x32_bf16 v[80:83], v[32:35], v[144:147], v[80:83]
  ds_read_b128 v[168:171], v251 offset:8192
  v_mfma_f32_16x16x32_bf16 v[84:87], v[36:39], v[144:147], v[84:87]
  ds_read_b128 v[172:175], v251 offset:10240
  s_waitcnt lgkmcnt(4)
  v_mfma_f32_16x16x32_bf16 v[88:91], v[32:35], v[148:151], v[88:91]
  ds_read_b128 v[160:163], v250 offset:8192
  v_mfma_f32_16x16x32_bf16 v[92:95], v[36:39], v[148:151], v[92:95]
  ds_read_b128 v[164:167], v250 offset:10240
  s_waitcnt lgkmcnt(5)
  v_mfma_f32_16x16x32_bf16 v[96:99], v[32:35], v[152:155], v[96:99]
  v_mfma_f32_16x16x32_bf16 v[100:103], v[36:39], v[152:155], v[100:103]
  s_waitcnt lgkmcnt(4)
  v_mfma_f32_16x16x32_bf16 v[104:107], v[32:35], v[156:159], v[104:107]
  v_mfma_f32_16x16x32_bf16 v[108:111], v[36:39], v[156:159], v[108:111]
  s_waitcnt vmcnt(6) lgkmcnt(3)
  v_mfma_f32_16x16x32_bf16 v[96:99], v[40:43], v[168:171], v[96:99]
  ds_read_b128 v[144:147], v248 offset:8192
  v_mfma_f32_16x16x32_bf16 v[100:103], v[44:47], v[168:171], v[100:103]
  ds_read_b128 v[148:151], v248 offset:10240
  s_waitcnt lgkmcnt(4)
  v_mfma_f32_16x16x32_bf16 v[104:107], v[40:43], v[172:175], v[104:107]
  ds_read_b128 v[152:155], v249 offset:8192
  v_mfma_f32_16x16x32_bf16 v[108:111], v[44:47], v[172:175], v[108:111]
  ds_read_b128 v[156:159], v249 offset:10240
  s_waitcnt lgkmcnt(5)
  v_mfma_f32_16x16x32_bf16 v[80:83], v[40:43], v[160:163], v[80:83]
  v_cvt_pk_bf16_f32 v232, v96, v97
  v_cvt_pk_bf16_f32 v233, v98, v99
  v_cvt_pk_bf16_f32 v234, v100, v101
  v_mfma_f32_16x16x32_bf16 v[84:87], v[44:47], v[160:163], v[84:87]
  v_cvt_pk_bf16_f32 v235, v102, v103
  ds_write_b128 v8, v[232:235]
  v_cvt_pk_bf16_f32 v236, v104, v105
  s_waitcnt lgkmcnt(5)
  v_mfma_f32_16x16x32_bf16 v[88:91], v[40:43], v[164:167], v[88:91]
  v_cvt_pk_bf16_f32 v237, v106, v107
  v_cvt_pk_bf16_f32 v238, v108, v109
  v_mfma_f32_16x16x32_bf16 v[92:95], v[44:47], v[164:167], v[92:95]
  v_cvt_pk_bf16_f32 v239, v110, v111
  ds_write_b128 v9, v[236:239]
  s_waitcnt lgkmcnt(0)
  s_barrier
  v_mfma_f32_16x16x32_bf16 v[192:195], v[112:115], v[144:147], v[192:195]
  ds_read_b128 v[96:99], v10
  ds_read_b128 v[100:103], v11
  v_mfma_f32_16x16x32_bf16 v[196:199], v[116:119], v[144:147], v[196:199]
  ds_read_b128 v[160:163], v248 offset:16384
  ds_read_b128 v[164:167], v248 offset:18432
  v_mfma_f32_16x16x32_bf16 v[200:203], v[112:115], v[148:151], v[200:203]
  ds_read_b128 v[168:171], v249 offset:16384
  v_mfma_f32_16x16x32_bf16 v[204:207], v[116:119], v[148:151], v[204:207]
  ds_read_b128 v[172:175], v249 offset:18432
  v_mfma_f32_16x16x32_bf16 v[208:211], v[112:115], v[152:155], v[208:211]
  s_add_u32 m0, s46, 49152
  s_add_u32 s61, s55, 114688
  buffer_load_dwordx4 v1, s[32:35], s61 offen lds
  v_mfma_f32_16x16x32_bf16 v[212:215], v[116:119], v[152:155], v[212:215]
  v_mfma_f32_16x16x32_bf16 v[216:219], v[112:115], v[156:159], v[216:219]
  v_mfma_f32_16x16x32_bf16 v[220:223], v[116:119], v[156:159], v[220:223]
  s_waitcnt lgkmcnt(3)
  v_mfma_f32_16x16x32_bf16 v[192:195], v[120:123], v[160:163], v[192:195]
  ds_read_b128 v[144:147], v250 offset:16384
  ds_read_b128 v[148:151], v250 offset:18432
  ds_read_b128 v[152:155], v251 offset:16384
  v_mfma_f32_16x16x32_bf16 v[196:199], v[124:127], v[160:163], v[196:199]
  ds_read_b128 v[156:159], v251 offset:18432
  s_waitcnt lgkmcnt(6)
  v_mfma_f32_16x16x32_bf16 v[200:203], v[120:123], v[164:167], v[200:203]
  v_mfma_f32_16x16x32_bf16 v[80:83], v[226:229], v[96:99], v[80:83]
  v_mfma_f32_16x16x32_bf16 v[84:87], v[224:227], v[96:99], v[84:87]
  v_mfma_f32_16x16x32_bf16 v[204:207], v[124:127], v[164:167], v[204:207]
  v_mfma_f32_16x16x32_bf16 v[88:91], v[226:229], v[100:103], v[88:91]
  v_mfma_f32_16x16x32_bf16 v[92:95], v[224:227], v[100:103], v[92:95]
  s_waitcnt lgkmcnt(5)
  v_mfma_f32_16x16x32_bf16 v[208:211], v[120:123], v[168:171], v[208:211]
  s_nop 1
  v_cvt_pk_bf16_f32 v232, v80, v81
  v_cvt_pk_bf16_f32 v233, v82, v83
  v_mfma_f32_16x16x32_bf16 v[212:215], v[124:127], v[168:171], v[212:215]
  v_cvt_pk_bf16_f32 v234, v84, v85
  v_cvt_pk_bf16_f32 v235, v86, v87
  s_waitcnt lgkmcnt(4)
  v_mfma_f32_16x16x32_bf16 v[216:219], v[120:123], v[172:175], v[216:219]
  s_xor_b32 s62, s73, 131072
  buffer_store_dwordx4 v[232:235], v5, s[16:19], s62 offen offset:0 sc1
  v_mfma_f32_16x16x32_bf16 v[220:223], v[124:127], v[172:175], v[220:223]
  s_add_u32 m0, s46, 57344
  s_add_u32 s61, s55, 172032
  buffer_load_dwordx4 v1, s[32:35], s61 offen lds
  s_waitcnt lgkmcnt(3)
  v_mfma_f32_16x16x32_bf16 v[192:195], v[128:131], v[144:147], v[192:195]
  ds_read_b128 v[160:163], v248 offset:24576
  ds_read_b128 v[164:167], v248 offset:26624
  v_mfma_f32_16x16x32_bf16 v[196:199], v[132:135], v[144:147], v[196:199]
  ds_read_b128 v[168:171], v249 offset:24576
  ds_read_b128 v[172:175], v249 offset:26624
  s_waitcnt lgkmcnt(6)
  v_mfma_f32_16x16x32_bf16 v[200:203], v[128:131], v[148:151], v[200:203]
  v_cvt_pk_bf16_f32 v236, v88, v89
  v_mfma_f32_16x16x32_bf16 v[204:207], v[132:135], v[148:151], v[204:207]
  v_cvt_pk_bf16_f32 v237, v90, v91
  s_waitcnt lgkmcnt(5)
  v_mfma_f32_16x16x32_bf16 v[208:211], v[128:131], v[152:155], v[208:211]
  v_cvt_pk_bf16_f32 v238, v92, v93
  v_mfma_f32_16x16x32_bf16 v[212:215], v[132:135], v[152:155], v[212:215]
  v_cvt_pk_bf16_f32 v239, v94, v95
  s_waitcnt lgkmcnt(4)
  v_mfma_f32_16x16x32_bf16 v[216:219], v[128:131], v[156:159], v[216:219]
  s_xor_b32 s62, s73, 131072
  buffer_store_dwordx4 v[236:239], v5, s[16:19], s62 offen offset:1024 sc1
  v_mfma_f32_16x16x32_bf16 v[220:223], v[132:135], v[156:159], v[220:223]
  s_add_u32 m0, s46, 122880
  s_add_u32 s61, s55, 229376
  buffer_load_dwordx4 v1, s[32:35], s61 offen lds
  s_waitcnt lgkmcnt(3)
  v_mfma_f32_16x16x32_bf16 v[192:195], v[136:139], v[160:163], v[192:195]
  ds_read_b128 v[144:147], v248 offset:32768
  ds_read_b128 v[148:151], v248 offset:34816
  v_mfma_f32_16x16x32_bf16 v[196:199], v[140:143], v[160:163], v[196:199]
  ds_read_b128 v[152:155], v249 offset:32768
  ds_read_b128 v[156:159], v249 offset:34816
  s_waitcnt lgkmcnt(6)
  v_mfma_f32_16x16x32_bf16 v[200:203], v[136:139], v[164:167], v[200:203]
  v_bfe_u32 v84, v0, 2, 3
  v_lshrrev_b32 v85, 5, v0
  v_mfma_f32_16x16x32_bf16 v[204:207], v[140:143], v[164:167], v[204:207]
  v_lshlrev_b32 v85, 10, v85
  s_waitcnt lgkmcnt(5)
  v_mfma_f32_16x16x32_bf16 v[208:211], v[136:139], v[168:171], v[208:211]
  v_lshl_add_u32 v85, v84, 7, v85
  v_and_b32 v86, 3, v0
  v_mfma_f32_16x16x32_bf16 v[212:215], v[140:143], v[168:171], v[212:215]
  v_lshl_add_u32 v85, v86, 3, v85
  s_waitcnt lgkmcnt(4)
  v_mfma_f32_16x16x32_bf16 v[216:219], v[136:139], v[172:175], v[216:219]
  v_lshrrev_b32 v84, 1, v84
  v_mfma_f32_16x16x32_bf16 v[220:223], v[140:143], v[172:175], v[220:223]
  s_add_u32 m0, s46, 65536
  s_add_u32 s61, s55, 286720
  buffer_load_dwordx4 v1, s[32:35], s61 offen lds
  s_waitcnt lgkmcnt(0)
  s_waitcnt vmcnt(11)
  s_barrier
  v_mfma_f32_16x16x32_bf16 v[192:195], v[48:51], v[144:147], v[192:195]
  ds_read_b128 v[160:163], v250 offset:24576
  ds_read_b128 v[164:167], v250 offset:26624
  v_mfma_f32_16x16x32_bf16 v[196:199], v[52:55], v[144:147], v[196:199]
  ds_read_b128 v[168:171], v251 offset:24576
  ds_read_b128 v[172:175], v251 offset:26624
  v_mfma_f32_16x16x32_bf16 v[200:203], v[48:51], v[148:151], v[200:203]
  v_lshl_or_b32 v80, v84, 5, v85
  s_mul_i32 s64, s45, 4160
  v_xor_b32 v80, s64, v80
  v_mfma_f32_16x16x32_bf16 v[204:207], v[52:55], v[148:151], v[204:207]
  v_xor_b32 v81, 32, v80
  v_mfma_f32_16x16x32_bf16 v[208:211], v[48:51], v[152:155], v[208:211]
  v_xor_b32 v82, 64, v80
  v_xor_b32 v83, 96, v80
  v_mfma_f32_16x16x32_bf16 v[212:215], v[52:55], v[152:155], v[212:215]
  v_add_u32 v84, 57344, v80
  v_mfma_f32_16x16x32_bf16 v[216:219], v[48:51], v[156:159], v[216:219]
  v_add_u32 v85, 57344, v81
  v_mfma_f32_16x16x32_bf16 v[220:223], v[52:55], v[156:159], v[220:223]
  s_add_u32 m0, s46, 73728
  s_add_u32 s61, s55, 344064
  buffer_load_dwordx4 v1, s[32:35], s61 offen lds
  s_waitcnt lgkmcnt(3)
  v_mfma_f32_16x16x32_bf16 v[192:195], v[56:59], v[160:163], v[192:195]
  ds_read_b128 v[144:147], v246 offset:0
  ds_read_b128 v[148:151], v246 offset:2048
  v_mfma_f32_16x16x32_bf16 v[196:199], v[60:63], v[160:163], v[196:199]
  ds_read_b128 v[152:155], v247 offset:0
  ds_read_b128 v[156:159], v247 offset:2048
  s_waitcnt lgkmcnt(6)
  v_mfma_f32_16x16x32_bf16 v[200:203], v[56:59], v[164:167], v[200:203]
  v_add_u32 v86, 57344, v82
  v_add_u32 v87, 57344, v83
  v_mfma_f32_16x16x32_bf16 v[204:207], v[60:63], v[164:167], v[204:207]
  v_add_u32 v88, 114688, v80
  s_waitcnt lgkmcnt(5)
  v_mfma_f32_16x16x32_bf16 v[208:211], v[56:59], v[168:171], v[208:211]
  v_add_u32 v89, 114688, v81
  v_mfma_f32_16x16x32_bf16 v[212:215], v[60:63], v[168:171], v[212:215]
  v_add_u32 v90, 114688, v82
  s_waitcnt lgkmcnt(4)
  v_mfma_f32_16x16x32_bf16 v[216:219], v[56:59], v[172:175], v[216:219]
  v_add_u32 v91, 114688, v83
  v_mfma_f32_16x16x32_bf16 v[220:223], v[60:63], v[172:175], v[220:223]
  s_add_u32 m0, s46, 131072
  s_add_u32 s61, s55, 401408
  buffer_load_dwordx4 v1, s[32:35], s61 offen lds
  s_waitcnt lgkmcnt(3)
  v_mfma_f32_16x16x32_bf16 v[192:195], v[64:67], v[144:147], v[192:195]
  ds_read_b128 v[160:163], v246 offset:8192
  v_mfma_f32_16x16x32_bf16 v[196:199], v[68:71], v[144:147], v[196:199]
  ds_read_b128 v[164:167], v246 offset:10240
  s_waitcnt lgkmcnt(4)
  v_mfma_f32_16x16x32_bf16 v[200:203], v[64:67], v[148:151], v[200:203]
  ds_read_b128 v[168:171], v247 offset:8192
  v_mfma_f32_16x16x32_bf16 v[204:207], v[68:71], v[148:151], v[204:207]
  ds_read_b128 v[172:175], v247 offset:10240
  s_waitcnt lgkmcnt(5)
  v_mfma_f32_16x16x32_bf16 v[208:211], v[64:67], v[152:155], v[208:211]
  s_add_u32 m0, s46, 81920
  s_add_u32 s61, s55, 458752
  buffer_load_dwordx4 v1, s[32:35], s61 offen lds
  v_mfma_f32_16x16x32_bf16 v[212:215], v[68:71], v[152:155], v[212:215]
  s_waitcnt lgkmcnt(4)
  v_mfma_f32_16x16x32_bf16 v[216:219], v[64:67], v[156:159], v[216:219]
  v_mfma_f32_16x16x32_bf16 v[220:223], v[68:71], v[156:159], v[220:223]
  s_waitcnt lgkmcnt(3)
  v_mfma_f32_16x16x32_bf16 v[192:195], v[72:75], v[160:163], v[192:195]
  ds_read_b128 v[144:147], v250 offset:32768
  v_mfma_f32_16x16x32_bf16 v[196:199], v[76:79], v[160:163], v[196:199]
  ds_read_b128 v[148:151], v250 offset:34816
  s_waitcnt lgkmcnt(4)
  v_mfma_f32_16x16x32_bf16 v[200:203], v[72:75], v[164:167], v[200:203]
  ds_read_b128 v[152:155], v251 offset:32768
  v_mfma_f32_16x16x32_bf16 v[204:207], v[76:79], v[164:167], v[204:207]
  ds_read_b128 v[156:159], v251 offset:34816
  s_waitcnt lgkmcnt(5)
  v_mfma_f32_16x16x32_bf16 v[208:211], v[72:75], v[168:171], v[208:211]
  ds_read_b128 v[252:255], v2
  v_mfma_f32_16x16x32_bf16 v[212:215], v[76:79], v[168:171], v[212:215]
  s_add_u32 m0, s46, 90112
  s_add_u32 s61, s55, 516096
  buffer_load_dwordx4 v1, s[32:35], s61 offen lds
  s_waitcnt lgkmcnt(5)
  v_mfma_f32_16x16x32_bf16 v[216:219], v[72:75], v[172:175], v[216:219]
  v_mfma_f32_16x16x32_bf16 v[220:223], v[76:79], v[172:175], v[220:223]
  s_waitcnt lgkmcnt(0)
  s_waitcnt vmcnt(12)
  s_barrier
  v_mfma_f32_16x16x32_bf16 v[192:195], v[16:19], v[144:147], v[192:195]
  ds_read_b128 v[160:163], v248 offset:40960
  v_mfma_f32_16x16x32_bf16 v[196:199], v[20:23], v[144:147], v[196:199]
  ds_read_b128 v[164:167], v248 offset:43008
  v_mfma_f32_16x16x32_bf16 v[200:203], v[16:19], v[148:151], v[200:203]
  ds_read_b128 v[168:171], v249 offset:40960
  v_mfma_f32_16x16x32_bf16 v[204:207], v[20:23], v[148:151], v[204:207]
  ds_read_b128 v[172:175], v249 offset:43008
  v_mfma_f32_16x16x32_bf16 v[208:211], v[16:19], v[152:155], v[208:211]
  buffer_load_dwordx4 v[104:107], v5, s[16:19], s73 offen offset:0 sc1
  v_mfma_f32_16x16x32_bf16 v[212:215], v[20:23], v[152:155], v[212:215]
  buffer_load_dwordx4 v[108:111], v5, s[16:19], s73 offen offset:1024 sc1
  v_mfma_f32_16x16x32_bf16 v[216:219], v[16:19], v[156:159], v[216:219]
  v_mfma_f32_16x16x32_bf16 v[220:223], v[20:23], v[156:159], v[220:223]
  s_cmp_lg_u32 s40, 3
  s_cbranch_scc1 OW_14
  v_and_b32 v244, 31, v0
  v_lshlrev_b32 v244, 2, v244
  s_mov_b32 s59, 98304
  buffer_load_dword v245, v244, s[16:19], s59 offen sc1
  s_nop 4
OW_14:
  s_waitcnt lgkmcnt(3)
  v_mfma_f32_16x16x32_bf16 v[192:195], v[24:27], v[160:163], v[192:195]
  ds_read_b128 v[144:147], v246 offset:16384
  v_mfma_f32_16x16x32_bf16 v[196:199], v[28:31], v[160:163], v[196:199]
  ds_read_b128 v[148:151], v246 offset:18432
  s_waitcnt lgkmcnt(4)
  v_mfma_f32_16x16x32_bf16 v[200:203], v[24:27], v[164:167], v[200:203]
  ds_read_b128 v[152:155], v247 offset:16384
  v_mfma_f32_16x16x32_bf16 v[204:207], v[28:31], v[164:167], v[204:207]
  ds_read_b128 v[156:159], v247 offset:18432
  s_waitcnt lgkmcnt(5)
  v_mfma_f32_16x16x32_bf16 v[208:211], v[24:27], v[168:171], v[208:211]
  s_add_u32 m0, s46, 139264
  s_add_u32 s61, s55, 573440
  buffer_load_dwordx4 v1, s[32:35], s61 offen lds
  v_mfma_f32_16x16x32_bf16 v[212:215], v[28:31], v[168:171], v[212:215]
  s_waitcnt lgkmcnt(4)
  v_mfma_f32_16x16x32_bf16 v[216:219], v[24:27], v[172:175], v[216:219]
  v_mfma_f32_16x16x32_bf16 v[220:223], v[28:31], v[172:175], v[220:223]
  s_waitcnt lgkmcnt(3)
  v_mfma_f32_16x16x32_bf16 v[192:195], v[32:35], v[144:147], v[192:195]
  ds_read_b128 v[168:171], v247 offset:24576
  v_mfma_f32_16x16x32_bf16 v[196:199], v[36:39], v[144:147], v[196:199]
  ds_read_b128 v[172:175], v247 offset:26624
  s_waitcnt lgkmcnt(4)
  v_mfma_f32_16x16x32_bf16 v[200:203], v[32:35], v[148:151], v[200:203]
  ds_read_b128 v[160:163], v246 offset:24576
  v_mfma_f32_16x16x32_bf16 v[204:207], v[36:39], v[148:151], v[204:207]
  ds_read_b128 v[164:167], v246 offset:26624
  s_waitcnt lgkmcnt(5)
  v_mfma_f32_16x16x32_bf16 v[208:211], v[32:35], v[152:155], v[208:211]
  s_add_u32 m0, s46, 0
  s_add_u32 s61, s55, 630784
  buffer_load_dwordx4 v1, s[32:35], s61 offen lds
  v_mfma_f32_16x16x32_bf16 v[212:215], v[36:39], v[152:155], v[212:215]
  s_waitcnt lgkmcnt(4)
  v_mfma_f32_16x16x32_bf16 v[216:219], v[32:35], v[156:159], v[216:219]
  v_mfma_f32_16x16x32_bf16 v[220:223], v[36:39], v[156:159], v[220:223]
  s_waitcnt lgkmcnt(3)
  v_mfma_f32_16x16x32_bf16 v[208:211], v[40:43], v[168:171], v[208:211]
  v_mfma_f32_16x16x32_bf16 v[212:215], v[44:47], v[168:171], v[212:215]
  s_waitcnt lgkmcnt(2)
  v_mfma_f32_16x16x32_bf16 v[216:219], v[40:43], v[172:175], v[216:219]
  v_mfma_f32_16x16x32_bf16 v[220:223], v[44:47], v[172:175], v[220:223]
  s_waitcnt lgkmcnt(1)
  v_mfma_f32_16x16x32_bf16 v[192:195], v[40:43], v[160:163], v[192:195]
  s_waitcnt vmcnt(2)
  v_max_u32 v14, v107, v111
  v_cmp_eq_u32 vcc, -1, v14
  s_cbranch_vccnz PF
PR:
  v_mfma_f32_16x16x32_bf16 v[192:195], v[226:229], v[104:107], v[192:195]
  v_mfma_f32_16x16x32_bf16 v[196:199], v[224:227], v[104:107], v[196:199]
  v_mfma_f32_16x16x32_bf16 v[200:203], v[226:229], v[108:111], v[200:203]
  v_mfma_f32_16x16x32_bf16 v[196:199], v[44:47], v[160:163], v[196:199]
  v_mfma_f32_16x16x32_bf16 v[204:207], v[224:227], v[108:111], v[204:207]
  v_cvt_pk_bf16_f32 v232, v208, v209
  v_cvt_pk_bf16_f32 v233, v210, v211
  v_cvt_pk_bf16_f32 v234, v212, v213
  s_waitcnt lgkmcnt(0)
  v_mfma_f32_16x16x32_bf16 v[200:203], v[40:43], v[164:167], v[200:203]
  v_cvt_pk_bf16_f32 v235, v214, v215
  ds_write_b128 v8, v[232:235]
  v_cvt_pk_bf16_f32 v236, v216, v217
  v_cvt_pk_bf16_f32 v237, v218, v219
  v_mfma_f32_16x16x32_bf16 v[204:207], v[44:47], v[164:167], v[204:207]
  v_cvt_pk_bf16_f32 v238, v220, v221
  v_cvt_pk_bf16_f32 v239, v222, v223
  ds_write_b128 v9, v[236:239]
  s_cmp_lg_u32 s40, 3
  s_cbranch_scc1 OW_15
  s_waitcnt vmcnt(2)
  s_movk_i32 s62, 0x1000
  s_branch PC_18
PL_16:
  buffer_load_dword v245, v244, s[16:19], s59 offen sc1
  s_waitcnt vmcnt(0)
PC_18:
  v_cmp_ne_u32 vcc, s43, v245
  s_nop 1
  s_cbranch_vccz PD_17
  s_sleep 2
  s_sub_u32 s62, s62, 1
  s_cbranch_scc0 PL_16
PD_17:
  s_nop 4
OW_15:
  s_waitcnt lgkmcnt(0)
  s_barrier
  ds_read_b128 v[208:211], v10
  ds_read_b128 v[212:215], v11
  ds_read_b64_tr_b16 v[144:145], v80 offset:40960
  ds_read_b64_tr_b16 v[146:147], v80 offset:43008
  ds_read_b64_tr_b16 v[148:149], v81 offset:40960
  ds_read_b64_tr_b16 v[150:151], v81 offset:43008
  ds_read_b64_tr_b16 v[152:153], v82 offset:40960
  ds_read_b64_tr_b16 v[154:155], v82 offset:43008
  ds_read_b64_tr_b16 v[156:157], v83 offset:40960
  ds_read_b64_tr_b16 v[158:159], v83 offset:43008
  s_add_u32 m0, s46, 8192
  s_add_u32 s61, s55, 688128
  buffer_load_dwordx4 v1, s[32:35], s61 offen lds
  s_waitcnt lgkmcnt(9)
  v_mfma_f32_16x16x32_bf16 v[192:195], v[226:229], v[208:211], v[192:195]
  v_mfma_f32_16x16x32_bf16 v[196:199], v[224:227], v[208:211], v[196:199]
  s_waitcnt lgkmcnt(8)
  v_mfma_f32_16x16x32_bf16 v[200:203], v[226:229], v[212:215], v[200:203]
  v_mfma_f32_16x16x32_bf16 v[204:207], v[224:227], v[212:215], v[204:207]
  s_add_u32 m0, s46, 147456
  s_add_u32 s61, s55, 745472
  buffer_load_dwordx4 v1, s[32:35], s61 offen lds
  s_nop 0
  v_pk_mul_f32 v[192:193], v[192:193], v[176:177]
  v_pk_mul_f32 v[194:195], v[194:195], v[178:179]
  v_pk_mul_f32 v[196:197], v[196:197], v[180:181]
  v_pk_mul_f32 v[198:199], v[198:199], v[182:183]
  v_cvt_pk_bf16_f32 v232, v192, v193
  v_cvt_pk_bf16_f32 v233, v194, v195
  v_cvt_pk_bf16_f32 v234, v196, v197
  v_cvt_pk_bf16_f32 v235, v198, v199
  v_and_b32 v235, -2, v235
  s_cmp_ge_u32 s53, 24
  s_cselect_b32 s101, 1, s101
  s_cmp_lg_u32 s101, 0
  s_cbranch_scc1 UW_0
  buffer_store_dwordx4 v[232:235], v5, s[16:19], s92 offen
UB_0:
  v_pk_mul_f32 v[200:201], v[200:201], v[184:185]
  v_pk_mul_f32 v[202:203], v[202:203], v[186:187]
  v_pk_mul_f32 v[204:205], v[204:205], v[188:189]
  v_pk_mul_f32 v[206:207], v[206:207], v[190:191]
  v_cvt_pk_bf16_f32 v236, v200, v201
  v_cvt_pk_bf16_f32 v237, v202, v203
  v_cvt_pk_bf16_f32 v238, v204, v205
  v_cvt_pk_bf16_f32 v239, v206, v207
  v_and_b32 v239, -2, v239
  s_cmp_lg_u32 s101, 0
  s_cbranch_scc1 UW_1
  buffer_store_dwordx4 v[236:239], v5, s[16:19], s93 offen
UB_1:
  ds_read_b64_tr_b16 v[160:161], v88 offset:0
  ds_read_b64_tr_b16 v[162:163], v88 offset:2048
  ds_read_b64_tr_b16 v[164:165], v89 offset:0
  ds_read_b64_tr_b16 v[166:167], v89 offset:2048
  ds_read_b64_tr_b16 v[168:169], v90 offset:0
  ds_read_b64_tr_b16 v[170:171], v90 offset:2048
  ds_read_b64_tr_b16 v[172:173], v91 offset:0
  ds_read_b64_tr_b16 v[174:175], v91 offset:2048
  ds_read_b64_tr_b16 v[92:93], v80 offset:49152
  ds_read_b64_tr_b16 v[94:95], v80 offset:51200
  ds_read_b64_tr_b16 v[96:97], v81 offset:49152
  ds_read_b64_tr_b16 v[98:99], v81 offset:51200
  ds_read_b64_tr_b16 v[100:101], v82 offset:49152
  ds_read_b64_tr_b16 v[102:103], v82 offset:51200
  ds_read_b64_tr_b16 v[104:105], v83 offset:49152
  ds_read_b64_tr_b16 v[106:107], v83 offset:51200
  s_add_u32 m0, s46, 98304
  s_add_u32 s61, s55, 0
  buffer_load_dwordx4 v1, s[28:31], s61 offen lds
  s_add_u32 m0, s46, 16384
  s_add_u32 s61, s55, 57344
  buffer_load_dwordx4 v1, s[28:31], s61 offen lds
  s_add_u32 m0, s46, 24576
  s_add_u32 s61, s55, 114688
  buffer_load_dwordx4 v1, s[28:31], s61 offen lds
  s_add_u32 s60, s57, 0
  buffer_load_dwordx4 v[16:19], v5, s[16:19], s60 offen sc1
  s_add_u32 s60, s57, 131072
  buffer_load_dwordx4 v[20:23], v5, s[16:19], s60 offen sc1
  s_add_u32 s60, s57, 262144
  buffer_load_dwordx4 v[24:27], v5, s[16:19], s60 offen sc1
  s_add_u32 s60, s57, 393216
  buffer_load_dwordx4 v[28:31], v5, s[16:19], s60 offen sc1
  s_add_u32 s60, s57, 524288
  buffer_load_dwordx4 v[32:35], v5, s[16:19], s60 offen sc1
  s_add_u32 s60, s57, 655360
  buffer_load_dwordx4 v[36:39], v5, s[16:19], s60 offen sc1
  v_permlane16_swap_b32 v252, v254
  v_permlane16_swap_b32 v253, v255
  v_lshlrev_b32 v176, 16, v252
  v_and_b32 v177, 0xffff0000, v252
  v_lshlrev_b32 v178, 16, v253
  v_and_b32 v179, 0xffff0000, v253
  v_lshlrev_b32 v180, 16, v254
  v_and_b32 v181, 0xffff0000, v254
  v_lshlrev_b32 v182, 16, v255
  v_and_b32 v183, 0xffff0000, v255
  s_waitcnt vmcnt(5)
  v_and_b32 v14, 1, v19
  v_cmp_ne_u32 vcc, 0, v14
  s_waitcnt lgkmcnt(15)
  s_cbranch_vccnz UF_0
UR_0:
  v_mfma_f32_16x16x32_bf16 v[184:187], v[152:155], v[16:19], 0
  ds_read_b64_tr_b16 v[192:193], v84 offset:0
  ds_read_b64_tr_b16 v[194:195], v84 offset:2048
  ds_read_b64_tr_b16 v[196:197], v85 offset:0
  v_mfma_f32_16x16x32_bf16 v[188:191], v[156:159], v[16:19], 0
  ds_read_b64_tr_b16 v[198:199], v85 offset:2048
  ds_read_b64_tr_b16 v[200:201], v86 offset:0
  v_mfma_f32_16x16x32_bf16 v[176:179], v[144:147], v[16:19], v[176:179]
  s_add_u32 s60, s57, 786432
  buffer_load_dwordx4 v[40:43], v5, s[16:19], s60 offen sc1
  ds_read_b64_tr_b16 v[202:203], v86 offset:2048
  v_mfma_f32_16x16x32_bf16 v[180:183], v[148:151], v[16:19], v[180:183]
  ds_read_b64_tr_b16 v[204:205], v87 offset:0
  ds_read_b64_tr_b16 v[206:207], v87 offset:2048
  s_waitcnt vmcnt(5)
  v_and_b32 v14, 1, v23
  v_cmp_ne_u32 vcc, 0, v14
  s_waitcnt lgkmcnt(15)
  s_cbranch_vccnz UF_1
UR_1:
  v_mfma_f32_16x16x32_bf16 v[176:179], v[160:163], v[20:23], v[176:179]
  ds_read_b64_tr_b16 v[208:209], v88 offset:8192
  ds_read_b64_tr_b16 v[210:211], v88 offset:10240
  ds_read_b64_tr_b16 v[212:213], v89 offset:8192
  v_mfma_f32_16x16x32_bf16 v[180:183], v[164:167], v[20:23], v[180:183]
  ds_read_b64_tr_b16 v[214:215], v89 offset:10240
  ds_read_b64_tr_b16 v[216:217], v90 offset:8192
  v_mfma_f32_16x16x32_bf16 v[184:187], v[168:171], v[20:23], v[184:187]
  s_add_u32 s60, s57, 917504
  buffer_load_dwordx4 v[44:47], v5, s[16:19], s60 offen sc1
  ds_read_b64_tr_b16 v[218:219], v90 offset:10240
  v_mfma_f32_16x16x32_bf16 v[188:191], v[172:175], v[20:23], v[188:191]
  ds_read_b64_tr_b16 v[220:221], v91 offset:8192
  ds_read_b64_tr_b16 v[222:223], v91 offset:10240
  s_waitcnt vmcnt(5)
  v_and_b32 v14, 1, v27
  v_cmp_ne_u32 vcc, 0, v14
  s_waitcnt lgkmcnt(15)
  s_cbranch_vccnz UF_2
UR_2:
  v_mfma_f32_16x16x32_bf16 v[176:179], v[92:95], v[24:27], v[176:179]
  ds_read_b64_tr_b16 v[144:145], v84 offset:8192
  ds_read_b64_tr_b16 v[146:147], v84 offset:10240
  ds_read_b64_tr_b16 v[148:149], v85 offset:8192
  v_mfma_f32_16x16x32_bf16 v[180:183], v[96:99], v[24:27], v[180:183]
  ds_read_b64_tr_b16 v[150:151], v85 offset:10240
  ds_read_b64_tr_b16 v[152:153], v86 offset:8192
  v_mfma_f32_16x16x32_bf16 v[184:187], v[100:103], v[24:27], v[184:187]
  s_add_u32 s60, s57, 1048576
  buffer_load_dwordx4 v[48:51], v5, s[16:19], s60 offen sc1
  ds_read_b64_tr_b16 v[154:155], v86 offset:10240
  v_mfma_f32_16x16x32_bf16 v[188:191], v[104:107], v[24:27], v[188:191]
  ds_read_b64_tr_b16 v[156:157], v87 offset:8192
  ds_read_b64_tr_b16 v[158:159], v87 offset:10240
  s_waitcnt vmcnt(5)
  v_and_b32 v14, 1, v31
  v_cmp_ne_u32 vcc, 0, v14
  s_waitcnt lgkmcnt(15)
  s_cbranch_vccnz UF_3
UR_3:
  v_mfma_f32_16x16x32_bf16 v[176:179], v[192:195], v[28:31], v[176:179]
  ds_read_b64_tr_b16 v[160:161], v84 offset:16384
  ds_read_b64_tr_b16 v[162:163], v84 offset:18432
  ds_read_b64_tr_b16 v[164:165], v85 offset:16384
  v_mfma_f32_16x16x32_bf16 v[180:183], v[196:199], v[28:31], v[180:183]
  ds_read_b64_tr_b16 v[166:167], v85 offset:18432
  ds_read_b64_tr_b16 v[168:169], v86 offset:16384
  v_mfma_f32_16x16x32_bf16 v[184:187], v[200:203], v[28:31], v[184:187]
  s_add_u32 s60, s57, 1179648
  buffer_load_dwordx4 v[52:55], v5, s[16:19], s60 offen sc1
  ds_read_b64_tr_b16 v[170:171], v86 offset:18432
  v_mfma_f32_16x16x32_bf16 v[188:191], v[204:207], v[28:31], v[188:191]
  ds_read_b64_tr_b16 v[172:173], v87 offset:16384
  ds_read_b64_tr_b16 v[174:175], v87 offset:18432
  s_waitcnt vmcnt(5)
  v_and_b32 v14, 1, v35
  v_cmp_ne_u32 vcc, 0, v14
  s_cbranch_vccnz UF_4
UR_4:
  s_waitcnt lgkmcnt(15)
  s_barrier
  v_mfma_f32_16x16x32_bf16 v[176:179], v[208:211], v[32:35], v[176:179]
  ds_read_b64_tr_b16 v[92:93], v88 offset:16384
  ds_read_b64_tr_b16 v[94:95], v88 offset:18432
  ds_read_b64_tr_b16 v[96:97], v89 offset:16384
  v_mfma_f32_16x16x32_bf16 v[180:183], v[212:215], v[32:35], v[180:183]
  s_add_u32 s60, s57, 1310720
  buffer_load_dwordx4 v[56:59], v5, s[16:19], s60 offen sc1
  ds_read_b64_tr_b16 v[98:99], v89 offset:18432
  ds_read_b64_tr_b16 v[100:101], v90 offset:16384
  v_mfma_f32_16x16x32_bf16 v[184:187], v[216:219], v[32:35], v[184:187]
  ds_read_b64_tr_b16 v[102:103], v90 offset:18432
  s_add_u32 m0, s46, 40960
  s_add_u32 s61, s55, 172032
  buffer_load_dwordx4 v1, s[28:31], s61 offen lds
  v_mfma_f32_16x16x32_bf16 v[188:191], v[220:223], v[32:35], v[188:191]
  ds_read_b64_tr_b16 v[104:105], v91 offset:16384
  ds_read_b64_tr_b16 v[106:107], v91 offset:18432
  s_waitcnt vmcnt(6)
  v_and_b32 v14, 1, v39
  v_cmp_ne_u32 vcc, 0, v14
  s_waitcnt lgkmcnt(15)
  s_cbranch_vccnz UF_5
UR_5:
  v_mfma_f32_16x16x32_bf16 v[176:179], v[144:147], v[36:39], v[176:179]
  ds_read_b64_tr_b16 v[192:193], v84 offset:24576
  ds_read_b64_tr_b16 v[194:195], v84 offset:26624
  ds_read_b64_tr_b16 v[196:197], v85 offset:24576
  v_mfma_f32_16x16x32_bf16 v[180:183], v[148:151], v[36:39], v[180:183]
  s_add_u32 s60, s57, 1441792
  buffer_load_dwordx4 v[60:63], v5, s[16:19], s60 offen sc1
  ds_read_b64_tr_b16 v[198:199], v85 offset:26624
  ds_read_b64_tr_b16 v[200:201], v86 offset:24576
  v_mfma_f32_16x16x32_bf16 v[184:187], v[152:155], v[36:39], v[184:187]
  ds_read_b64_tr_b16 v[202:203], v86 offset:26624
  s_add_u32 m0, s46, 114688
  s_add_u32 s61, s55, 229376
  buffer_load_dwordx4 v1, s[28:31], s61 offen lds
  v_mfma_f32_16x16x32_bf16 v[188:191], v[156:159], v[36:39], v[188:191]
  ds_read_b64_tr_b16 v[204:205], v87 offset:24576
  ds_read_b64_tr_b16 v[206:207], v87 offset:26624
  s_waitcnt vmcnt(7)
  v_and_b32 v14, 1, v43
  v_cmp_ne_u32 vcc, 0, v14
  s_waitcnt lgkmcnt(15)
  s_cbranch_vccnz UF_6
UR_6:
  v_mfma_f32_16x16x32_bf16 v[176:179], v[160:163], v[40:43], v[176:179]
  ds_read_b64_tr_b16 v[208:209], v84 offset:32768
  ds_read_b64_tr_b16 v[210:211], v84 offset:34816
  ds_read_b64_tr_b16 v[212:213], v85 offset:32768
  v_mfma_f32_16x16x32_bf16 v[180:183], v[164:167], v[40:43], v[180:183]
  s_add_u32 s60, s57, 1572864
  buffer_load_dwordx4 v[64:67], v5, s[16:19], s60 offen sc1
  ds_read_b64_tr_b16 v[214:215], v85 offset:34816
  ds_read_b64_tr_b16 v[216:217], v86 offset:32768
  v_mfma_f32_16x16x32_bf16 v[184:187], v[168:171], v[40:43], v[184:187]
  ds_read_b64_tr_b16 v[218:219], v86 offset:34816
  s_add_u32 m0, s46, 49152
  s_add_u32 s61, s55, 286720
  buffer_load_dwordx4 v1, s[28:31], s61 offen lds
  v_mfma_f32_16x16x32_bf16 v[188:191], v[172:175], v[40:43], v[188:191]
  ds_read_b64_tr_b16 v[220:221], v87 offset:32768
  ds_read_b64_tr_b16 v[222:223], v87 offset:34816
  s_waitcnt vmcnt(8)
  v_and_b32 v14, 1, v47
  v_cmp_ne_u32 vcc, 0, v14
  s_waitcnt lgkmcnt(15)
  s_cbranch_vccnz UF_7
UR_7:
  v_mfma_f32_16x16x32_bf16 v[176:179], v[92:95], v[44:47], v[176:179]
  ds_read_b64_tr_b16 v[144:145], v88 offset:24576
  ds_read_b64_tr_b16 v[146:147], v88 offset:26624
  ds_read_b64_tr_b16 v[148:149], v89 offset:24576
  v_mfma_f32_16x16x32_bf16 v[180:183], v[96:99], v[44:47], v[180:183]
  s_add_u32 s60, s57, 1703936
  buffer_load_dwordx4 v[68:71], v5, s[16:19], s60 offen sc1
  ds_read_b64_tr_b16 v[150:151], v89 offset:26624
  ds_read_b64_tr_b16 v[152:153], v90 offset:24576
  v_mfma_f32_16x16x32_bf16 v[184:187], v[100:103], v[44:47], v[184:187]
  ds_read_b64_tr_b16 v[154:155], v90 offset:26624
  s_add_u32 m0, s46, 57344
  s_add_u32 s61, s55, 344064
  buffer_load_dwordx4 v1, s[28:31], s61 offen lds
  v_mfma_f32_16x16x32_bf16 v[188:191], v[104:107], v[44:47], v[188:191]
  ds_read_b64_tr_b16 v[156:157], v91 offset:24576
  ds_read_b64_tr_b16 v[158:159], v91 offset:26624
  s_waitcnt vmcnt(9)
  v_and_b32 v14, 1, v51
  v_cmp_ne_u32 vcc, 0, v14
  s_waitcnt lgkmcnt(15)
  s_cbranch_vccnz UF_8
UR_8:
  v_mfma_f32_16x16x32_bf16 v[176:179], v[192:195], v[48:51], v[176:179]
  ds_read_b64_tr_b16 v[160:161], v80 offset:0
  ds_read_b64_tr_b16 v[162:163], v80 offset:2048
  ds_read_b64_tr_b16 v[164:165], v81 offset:0
  v_mfma_f32_16x16x32_bf16 v[180:183], v[196:199], v[48:51], v[180:183]
  s_add_u32 s60, s54, 0
  buffer_load_dwordx4 v[112:115], v5, s[16:19], s60 offen sc1
  ds_read_b64_tr_b16 v[166:167], v81 offset:2048
  ds_read_b64_tr_b16 v[168:169], v82 offset:0
  v_mfma_f32_16x16x32_bf16 v[184:187], v[200:203], v[48:51], v[184:187]
  ds_read_b64_tr_b16 v[170:171], v82 offset:2048
  s_add_u32 s60, s54, 2048
  buffer_load_dwordx4 v[116:119], v5, s[16:19], s60 offen sc1
  v_mfma_f32_16x16x32_bf16 v[188:191], v[204:207], v[48:51], v[188:191]
  ds_read_b64_tr_b16 v[172:173], v83 offset:0
  ds_read_b64_tr_b16 v[174:175], v83 offset:2048
  s_waitcnt vmcnt(10)
  v_and_b32 v14, 1, v55
  v_cmp_ne_u32 vcc, 0, v14
  s_waitcnt lgkmcnt(15)
  s_cbranch_vccnz UF_9
UR_9:
  v_mfma_f32_16x16x32_bf16 v[176:179], v[208:211], v[52:55], v[176:179]
  ds_read_b64_tr_b16 v[92:93], v80 offset:8192
  ds_read_b64_tr_b16 v[94:95], v80 offset:10240
  ds_read_b64_tr_b16 v[96:97], v81 offset:8192
  v_mfma_f32_16x16x32_bf16 v[180:183], v[212:215], v[52:55], v[180:183]
  s_add_u32 s60, s54, 4096
  buffer_load_dwordx4 v[120:123], v5, s[16:19], s60 offen sc1
  ds_read_b64_tr_b16 v[98:99], v81 offset:10240
  ds_read_b64_tr_b16 v[100:101], v82 offset:8192
  v_mfma_f32_16x16x32_bf16 v[184:187], v[216:219], v[52:55], v[184:187]
  ds_read_b64_tr_b16 v[102:103], v82 offset:10240
  s_add_u32 s60, s54, 6144
  buffer_load_dwordx4 v[124:127], v5, s[16:19], s60 offen sc1
  v_mfma_f32_16x16x32_bf16 v[188:191], v[220:223], v[52:55], v[188:191]
  ds_read_b64_tr_b16 v[104:105], v83 offset:8192
  ds_read_b64_tr_b16 v[106:107], v83 offset:10240
  s_waitcnt vmcnt(11)
  v_and_b32 v14, 1, v59
  v_cmp_ne_u32 vcc, 0, v14
  s_waitcnt lgkmcnt(15)
  s_cbranch_vccnz UF_10
UR_10:
  v_mfma_f32_16x16x32_bf16 v[176:179], v[144:147], v[56:59], v[176:179]
  ds_read_b64_tr_b16 v[192:193], v88 offset:32768
  ds_read_b64_tr_b16 v[194:195], v88 offset:34816
  ds_read_b64_tr_b16 v[196:197], v89 offset:32768
  v_mfma_f32_16x16x32_bf16 v[180:183], v[148:151], v[56:59], v[180:183]
  s_add_u32 s60, s54, 8192
  buffer_load_dwordx4 v[128:131], v5, s[16:19], s60 offen sc1
  ds_read_b64_tr_b16 v[198:199], v89 offset:34816
  ds_read_b64_tr_b16 v[200:201], v90 offset:32768
  v_mfma_f32_16x16x32_bf16 v[184:187], v[152:155], v[56:59], v[184:187]
  ds_read_b64_tr_b16 v[202:203], v90 offset:34816
  s_add_u32 s60, s54, 10240
  buffer_load_dwordx4 v[132:135], v5, s[16:19], s60 offen sc1
  v_mfma_f32_16x16x32_bf16 v[188:191], v[156:159], v[56:59], v[188:191]
  ds_read_b64_tr_b16 v[204:205], v91 offset:32768
  ds_read_b64_tr_b16 v[206:207], v91 offset:34816
  s_waitcnt vmcnt(11)
  v_and_b32 v14, 1, v63
  v_cmp_ne_u32 vcc, 0, v14
  s_waitcnt lgkmcnt(15)
  s_cbranch_vccnz UF_11
UR_11:
  v_mfma_f32_16x16x32_bf16 v[176:179], v[160:163], v[60:63], v[176:179]
  ds_read_b64_tr_b16 v[208:209], v84 offset:40960
  ds_read_b64_tr_b16 v[210:211], v84 offset:43008
  ds_read_b64_tr_b16 v[212:213], v85 offset:40960
  v_mfma_f32_16x16x32_bf16 v[180:183], v[164:167], v[60:63], v[180:183]
  ds_read_b64_tr_b16 v[214:215], v85 offset:43008
  ds_read_b64_tr_b16 v[216:217], v86 offset:40960
  v_mfma_f32_16x16x32_bf16 v[184:187], v[168:171], v[60:63], v[184:187]
  s_add_u32 s60, s54, 12288
  buffer_load_dwordx4 v[136:139], v5, s[16:19], s60 offen sc1
  ds_read_b64_tr_b16 v[218:219], v86 offset:43008
  v_mfma_f32_16x16x32_bf16 v[188:191], v[172:175], v[60:63], v[188:191]
  ds_read_b64_tr_b16 v[220:221], v87 offset:40960
  ds_read_b64_tr_b16 v[222:223], v87 offset:43008
  s_waitcnt vmcnt(10)
  v_and_b32 v14, 1, v67
  v_cmp_ne_u32 vcc, 0, v14
  s_waitcnt lgkmcnt(15)
  s_cbranch_vccnz UF_12
UR_12:
  v_mfma_f32_16x16x32_bf16 v[176:179], v[92:95], v[64:67], v[176:179]
  ds_read_b64_tr_b16 v[144:145], v80 offset:16384
  ds_read_b64_tr_b16 v[146:147], v80 offset:18432
  v_mfma_f32_16x16x32_bf16 v[180:183], v[96:99], v[64:67], v[180:183]
  ds_read_b64_tr_b16 v[148:149], v81 offset:16384
  ds_read_b64_tr_b16 v[150:151], v81 offset:18432
  v_mfma_f32_16x16x32_bf16 v[184:187], v[100:103], v[64:67], v[184:187]
  ds_read_b64_tr_b16 v[152:153], v82 offset:16384
  ds_read_b64_tr_b16 v[154:155], v82 offset:18432
  v_mfma_f32_16x16x32_bf16 v[188:191], v[104:107], v[64:67], v[188:191]
  ds_read_b64_tr_b16 v[156:157], v83 offset:16384
  ds_read_b64_tr_b16 v[158:159], v83 offset:18432
  s_waitcnt vmcnt(8)
  v_and_b32 v14, 1, v71
  v_cmp_ne_u32 vcc, 0, v14
  s_cbranch_vccnz UF_13
UR_13:
  s_waitcnt vmcnt(7) lgkmcnt(15)
  s_barrier
  v_mfma_f32_16x16x32_bf16 v[176:179], v[192:195], v[68:71], v[176:179]
  ds_read_b64_tr_b16 v[160:161], v80 offset:24576
  ds_read_b64_tr_b16 v[162:163], v80 offset:26624
  v_mfma_f32_16x16x32_bf16 v[180:183], v[196:199], v[68:71], v[180:183]
  ds_read_b64_tr_b16 v[164:165], v81 offset:24576
  ds_read_b64_tr_b16 v[166:167], v81 offset:26624
  v_mfma_f32_16x16x32_bf16 v[184:187], v[200:203], v[68:71], v[184:187]
  ds_read_b64_tr_b16 v[168:169], v82 offset:24576
  ds_read_b64_tr_b16 v[170:171], v82 offset:26624
  v_mfma_f32_16x16x32_bf16 v[188:191], v[204:207], v[68:71], v[188:191]
  ds_read_b64_tr_b16 v[172:173], v83 offset:24576
  ds_read_b64_tr_b16 v[174:175], v83 offset:26624
  s_waitcnt vmcnt(6)
  v_cmp_eq_u32 vcc, -1, v115
  s_waitcnt lgkmcnt(15)
  s_cbranch_vccnz UF_14
UR_14:
  v_mfma_f32_16x16x32_bf16 v[176:179], v[208:211], v[112:115], v[176:179]
  ds_read_b64_tr_b16 v[92:93], v80 offset:40960
  ds_read_b64_tr_b16 v[94:95], v80 offset:43008
  v_mfma_f32_16x16x32_bf16 v[180:183], v[212:215], v[112:115], v[180:183]
  ds_read_b64_tr_b16 v[96:97], v81 offset:40960
  ds_read_b64_tr_b16 v[98:99], v81 offset:43008
  v_mfma_f32_16x16x32_bf16 v[184:187], v[216:219], v[112:115], v[184:187]
  ds_read_b64_tr_b16 v[100:101], v82 offset:40960
  ds_read_b64_tr_b16 v[102:103], v82 offset:43008
  v_mfma_f32_16x16x32_bf16 v[188:191], v[220:223], v[112:115], v[188:191]
  ds_read_b64_tr_b16 v[104:105], v83 offset:40960
  ds_read_b64_tr_b16 v[106:107], v83 offset:43008
  s_waitcnt vmcnt(5)
  v_cmp_eq_u32 vcc, -1, v119
  s_waitcnt lgkmcnt(15)
  s_cbranch_vccnz UF_15
UR_15:
  v_mfma_f32_16x16x32_bf16 v[176:179], v[144:147], v[116:119], v[176:179]
  ds_read_b64_tr_b16 v[192:193], v88 offset:0
  ds_read_b64_tr_b16 v[194:195], v88 offset:2048
  v_mfma_f32_16x16x32_bf16 v[180:183], v[148:151], v[116:119], v[180:183]
  ds_read_b64_tr_b16 v[196:197], v89 offset:0
  ds_read_b64_tr_b16 v[198:199], v89 offset:2048
  v_mfma_f32_16x16x32_bf16 v[184:187], v[152:155], v[116:119], v[184:187]
  ds_read_b64_tr_b16 v[200:201], v90 offset:0
  ds_read_b64_tr_b16 v[202:203], v90 offset:2048
  v_mfma_f32_16x16x32_bf16 v[188:191], v[156:159], v[116:119], v[188:191]
  ds_read_b64_tr_b16 v[204:205], v91 offset:0
  ds_read_b64_tr_b16 v[206:207], v91 offset:2048
  s_waitcnt vmcnt(4)
  v_cmp_eq_u32 vcc, -1, v123
  s_waitcnt lgkmcnt(15)
  s_cbranch_vccnz UF_16
UR_16:
  v_mfma_f32_16x16x32_bf16 v[176:179], v[160:163], v[120:123], v[176:179]
  ds_read_b64_tr_b16 v[208:209], v80 offset:49152
  ds_read_b64_tr_b16 v[210:211], v80 offset:51200
  v_mfma_f32_16x16x32_bf16 v[180:183], v[164:167], v[120:123], v[180:183]
  ds_read_b64_tr_b16 v[212:213], v81 offset:49152
  ds_read_b64_tr_b16 v[214:215], v81 offset:51200
  v_mfma_f32_16x16x32_bf16 v[184:187], v[168:171], v[120:123], v[184:187]
  ds_read_b64_tr_b16 v[216:217], v82 offset:49152
  ds_read_b64_tr_b16 v[218:219], v82 offset:51200
  v_mfma_f32_16x16x32_bf16 v[188:191], v[172:175], v[120:123], v[188:191]
  ds_read_b64_tr_b16 v[220:221], v83 offset:49152
  ds_read_b64_tr_b16 v[222:223], v83 offset:51200
  s_and_b32 s64, s41, 3
  s_xor_b32 s64, s64, 1
  s_xor_b32 s65, s42, 3
  s_or_b32 s64, s64, s65
  s_xor_b32 s65, s40, 7
  s_or_b32 s64, s64, s65
  s_cbranch_scc0 L_WB
  buffer_load_dword v245, off, s[24:27], 0
L_WBR:
  s_waitcnt vmcnt(4)
  v_cmp_eq_u32 vcc, -1, v127
  s_waitcnt lgkmcnt(15)
  s_cbranch_vccnz UF_17
UR_17:
  v_mfma_f32_16x16x32_bf16 v[176:179], v[92:95], v[124:127], v[176:179]
  ds_read_b64_tr_b16 v[144:145], v84 offset:0
  ds_read_b64_tr_b16 v[146:147], v84 offset:2048
  v_mfma_f32_16x16x32_bf16 v[180:183], v[96:99], v[124:127], v[180:183]
  ds_read_b64_tr_b16 v[148:149], v85 offset:0
  ds_read_b64_tr_b16 v[150:151], v85 offset:2048
  v_mfma_f32_16x16x32_bf16 v[184:187], v[100:103], v[124:127], v[184:187]
  ds_read_b64_tr_b16 v[152:153], v86 offset:0
  ds_read_b64_tr_b16 v[154:155], v86 offset:2048
  v_mfma_f32_16x16x32_bf16 v[188:191], v[104:107], v[124:127], v[188:191]
  ds_read_b64_tr_b16 v[156:157], v87 offset:0
  ds_read_b64_tr_b16 v[158:159], v87 offset:2048
  s_waitcnt vmcnt(3)
  v_cmp_eq_u32 vcc, -1, v131
  s_waitcnt lgkmcnt(15)
  s_cbranch_vccnz UF_18
UR_18:
  v_mfma_f32_16x16x32_bf16 v[176:179], v[192:195], v[128:131], v[176:179]
  v_mfma_f32_16x16x32_bf16 v[180:183], v[196:199], v[128:131], v[180:183]
  v_mfma_f32_16x16x32_bf16 v[184:187], v[200:203], v[128:131], v[184:187]
  v_mfma_f32_16x16x32_bf16 v[188:191], v[204:207], v[128:131], v[188:191]
  s_waitcnt vmcnt(2)
  v_cmp_eq_u32 vcc, -1, v135
  s_waitcnt lgkmcnt(8)
  s_cbranch_vccnz UF_19
UR_19:
  v_mfma_f32_16x16x32_bf16 v[176:179], v[208:211], v[132:135], v[176:179]
  v_mfma_f32_16x16x32_bf16 v[180:183], v[212:215], v[132:135], v[180:183]
  v_mfma_f32_16x16x32_bf16 v[184:187], v[216:219], v[132:135], v[184:187]
  v_mfma_f32_16x16x32_bf16 v[188:191], v[220:223], v[132:135], v[188:191]
  s_waitcnt vmcnt(1)
  v_cmp_eq_u32 vcc, -1, v139
  s_waitcnt lgkmcnt(0)
  s_cbranch_vccnz UF_20
UR_20:
  v_mfma_f32_16x16x32_bf16 v[184:187], v[152:155], v[136:139], v[184:187]
  v_mfma_f32_16x16x32_bf16 v[188:191], v[156:159], v[136:139], v[188:191]
  v_mfma_f32_16x16x32_bf16 v[176:179], v[144:147], v[136:139], v[176:179]
  v_mfma_f32_16x16x32_bf16 v[180:183], v[148:151], v[136:139], v[180:183]
  s_nop 4
  ds_write_b128 v8, v[184:187]
  ds_write_b128 v9, v[188:191]
  s_waitcnt lgkmcnt(0)
  s_barrier
  ds_read_b128 v[24:27], v10
  ds_read_b128 v[28:31], v11
  s_waitcnt lgkmcnt(1)
  v_pk_add_f32 v[176:177], v[176:177], v[24:25]
  v_pk_add_f32 v[178:179], v[178:179], v[26:27]
  s_waitcnt lgkmcnt(0)
  v_pk_add_f32 v[180:181], v[180:181], v[28:29]
  v_pk_add_f32 v[182:183], v[182:183], v[30:31]
  v_cvt_pk_bf16_f32 v24, v176, v177
  v_cvt_pk_bf16_f32 v25, v178, v179
  v_cvt_pk_bf16_f32 v26, v180, v181
  v_cvt_pk_bf16_f32 v27, v182, v183
  s_nop 0
  v_permlane16_swap_b32 v24, v26
  v_permlane16_swap_b32 v25, v27
  buffer_store_dwordx4 v[24:27], v3, s[36:39], s58 offen sc1 nt
  s_branch L_END
PF:
  s_movk_i32 s62, 0x1000
PL:
  buffer_load_dwordx4 v[104:107], v5, s[16:19], s73 offen offset:0 sc1
  buffer_load_dwordx4 v[108:111], v5, s[16:19], s73 offen offset:1024 sc1
  s_waitcnt vmcnt(0)
  v_max3_u32 v14, v104, v105, v106
  v_max3_u32 v14, v14, v107, v108
  v_max3_u32 v14, v14, v109, v110
  v_max_u32 v14, v14, v111
  v_cmp_eq_u32 vcc, -1, v14
  s_cbranch_vccz PR
  s_sub_u32 s62, s62, 1
  s_cbranch_scc0 PL
  s_branch PR
UW_0:
  buffer_store_dwordx4 v[232:235], v5, s[16:19], s92 offen sc1
  s_branch UB_0
UW_1:
  buffer_store_dwordx4 v[236:239], v5, s[16:19], s93 offen sc1
  s_branch UB_1
L_WB:
  buffer_wbl2 sc1
  s_branch L_WBR
UF_0:
  s_movk_i32 s63, 0
  s_movk_i32 s59, 6
  s_branch UF
UF_1:
  s_movk_i32 s63, 1
  s_movk_i32 s59, 7
  s_branch UF
UF_2:
  s_movk_i32 s63, 2
  s_movk_i32 s59, 8
  s_branch UF
UF_3:
  s_movk_i32 s63, 3
  s_movk_i32 s59, 9
  s_branch UF
UF_4:
  s_movk_i32 s63, 4
  s_movk_i32 s59, 10
  s_branch UF
UF_5:
  s_movk_i32 s63, 5
  s_movk_i32 s59, 11
  s_branch UF
UF_6:
  s_movk_i32 s63, 6
  s_movk_i32 s59, 12
  s_branch UF
UF_7:
  s_movk_i32 s63, 7
  s_movk_i32 s59, 13
  s_branch UF
UF_8:
  s_movk_i32 s63, 8
  s_movk_i32 s59, 14
  s_branch UF
UF_9:
  s_movk_i32 s63, 9
  s_movk_i32 s59, 16
  s_branch UF
UF_10:
  s_movk_i32 s63, 10
  s_movk_i32 s59, 18
  s_branch UF
UF_11:
  s_movk_i32 s63, 11
  s_movk_i32 s59, 20
  s_branch UF
UF_12:
  s_movk_i32 s63, 12
  s_movk_i32 s59, 21
  s_branch UF
UF_13:
  s_movk_i32 s63, 13
  s_movk_i32 s59, 21
  s_branch UF
UF_14:
  s_movk_i32 s63, 14
  s_movk_i32 s59, 21
  s_branch UF
UF_15:
  s_movk_i32 s63, 15
  s_movk_i32 s59, 21
  s_branch UF
UF_16:
  s_movk_i32 s63, 16
  s_movk_i32 s59, 21
  s_branch UF
UF_17:
  s_movk_i32 s63, 17
  s_movk_i32 s59, 21
  s_branch UF
UF_18:
  s_movk_i32 s63, 18
  s_movk_i32 s59, 21
  s_branch UF
UF_19:
  s_movk_i32 s63, 19
  s_movk_i32 s59, 21
  s_branch UF
UF_20:
  s_movk_i32 s63, 20
  s_movk_i32 s59, 21
  s_branch UF
UF:
  s_movk_i32 s62, 0x1000
UL:
  s_waitcnt vmcnt(0)
  s_mov_b32 s61, 0
  s_cmp_le_u32 s59, 0
  s_cbranch_scc1 UN_20
  s_cmp_gt_u32 s63, 0
  s_cbranch_scc1 UN_0
  v_and_b32 v14, 1, v19
  v_cmp_ne_u32 vcc, 0, v14
  s_cbranch_vccz UN_0
  s_add_u32 s60, s57, 0
  s_mov_b32 s61, 1
  buffer_load_dwordx4 v[16:19], v5, s[16:19], s60 offen sc1
UN_0:
  s_cmp_le_u32 s59, 1
  s_cbranch_scc1 UN_20
  s_cmp_gt_u32 s63, 1
  s_cbranch_scc1 UN_1
  v_and_b32 v14, 1, v23
  v_cmp_ne_u32 vcc, 0, v14
  s_cbranch_vccz UN_1
  s_add_u32 s60, s57, 131072
  s_mov_b32 s61, 1
  buffer_load_dwordx4 v[20:23], v5, s[16:19], s60 offen sc1
UN_1:
  s_cmp_le_u32 s59, 2
  s_cbranch_scc1 UN_20
  s_cmp_gt_u32 s63, 2
  s_cbranch_scc1 UN_2
  v_and_b32 v14, 1, v27
  v_cmp_ne_u32 vcc, 0, v14
  s_cbranch_vccz UN_2
  s_add_u32 s60, s57, 262144
  s_mov_b32 s61, 1
  buffer_load_dwordx4 v[24:27], v5, s[16:19], s60 offen sc1
UN_2:
  s_cmp_le_u32 s59, 3
  s_cbranch_scc1 UN_20
  s_cmp_gt_u32 s63, 3
  s_cbranch_scc1 UN_3
  v_and_b32 v14, 1, v31
  v_cmp_ne_u32 vcc, 0, v14
  s_cbranch_vccz UN_3
  s_add_u32 s60, s57, 393216
  s_mov_b32 s61, 1
  buffer_load_dwordx4 v[28:31], v5, s[16:19], s60 offen sc1
UN_3:
  s_cmp_le_u32 s59, 4
  s_cbranch_scc1 UN_20
  s_cmp_gt_u32 s63, 4
  s_cbranch_scc1 UN_4
  v_and_b32 v14, 1, v35
  v_cmp_ne_u32 vcc, 0, v14
  s_cbranch_vccz UN_4
  s_add_u32 s60, s57, 524288
  s_mov_b32 s61, 1
  buffer_load_dwordx4 v[32:35], v5, s[16:19], s60 offen sc1
UN_4:
  s_cmp_le_u32 s59, 5
  s_cbranch_scc1 UN_20
  s_cmp_gt_u32 s63, 5
  s_cbranch_scc1 UN_5
  v_and_b32 v14, 1, v39
  v_cmp_ne_u32 vcc, 0, v14
  s_cbranch_vccz UN_5
  s_add_u32 s60, s57, 655360
  s_mov_b32 s61, 1
  buffer_load_dwordx4 v[36:39], v5, s[16:19], s60 offen sc1
UN_5:
  s_cmp_le_u32 s59, 6
  s_cbranch_scc1 UN_20
  s_cmp_gt_u32 s63, 6
  s_cbranch_scc1 UN_6
  v_and_b32 v14, 1, v43
  v_cmp_ne_u32 vcc, 0, v14
  s_cbranch_vccz UN_6
  s_add_u32 s60, s57, 786432
  s_mov_b32 s61, 1
  buffer_load_dwordx4 v[40:43], v5, s[16:19], s60 offen sc1
UN_6:
  s_cmp_le_u32 s59, 7
  s_cbranch_scc1 UN_20
  s_cmp_gt_u32 s63, 7
  s_cbranch_scc1 UN_7
  v_and_b32 v14, 1, v47
  v_cmp_ne_u32 vcc, 0, v14
  s_cbranch_vccz UN_7
  s_add_u32 s60, s57, 917504
  s_mov_b32 s61, 1
  buffer_load_dwordx4 v[44:47], v5, s[16:19], s60 offen sc1
UN_7:
  s_cmp_le_u32 s59, 8
  s_cbranch_scc1 UN_20
  s_cmp_gt_u32 s63, 8
  s_cbranch_scc1 UN_8
  v_and_b32 v14, 1, v51
  v_cmp_ne_u32 vcc, 0, v14
  s_cbranch_vccz UN_8
  s_add_u32 s60, s57, 1048576
  s_mov_b32 s61, 1
  buffer_load_dwordx4 v[48:51], v5, s[16:19], s60 offen sc1
UN_8:
  s_cmp_le_u32 s59, 9
  s_cbranch_scc1 UN_20
  s_cmp_gt_u32 s63, 9
  s_cbranch_scc1 UN_9
  v_and_b32 v14, 1, v55
  v_cmp_ne_u32 vcc, 0, v14
  s_cbranch_vccz UN_9
  s_add_u32 s60, s57, 1179648
  s_mov_b32 s61, 1
  buffer_load_dwordx4 v[52:55], v5, s[16:19], s60 offen sc1
UN_9:
  s_cmp_le_u32 s59, 10
  s_cbranch_scc1 UN_20
  s_cmp_gt_u32 s63, 10
  s_cbranch_scc1 UN_10
  v_and_b32 v14, 1, v59
  v_cmp_ne_u32 vcc, 0, v14
  s_cbranch_vccz UN_10
  s_add_u32 s60, s57, 1310720
  s_mov_b32 s61, 1
  buffer_load_dwordx4 v[56:59], v5, s[16:19], s60 offen sc1
UN_10:
  s_cmp_le_u32 s59, 11
  s_cbranch_scc1 UN_20
  s_cmp_gt_u32 s63, 11
  s_cbranch_scc1 UN_11
  v_and_b32 v14, 1, v63
  v_cmp_ne_u32 vcc, 0, v14
  s_cbranch_vccz UN_11
  s_add_u32 s60, s57, 1441792
  s_mov_b32 s61, 1
  buffer_load_dwordx4 v[60:63], v5, s[16:19], s60 offen sc1
UN_11:
  s_cmp_le_u32 s59, 12
  s_cbranch_scc1 UN_20
  s_cmp_gt_u32 s63, 12
  s_cbranch_scc1 UN_12
  v_and_b32 v14, 1, v67
  v_cmp_ne_u32 vcc, 0, v14
  s_cbranch_vccz UN_12
  s_add_u32 s60, s57, 1572864
  s_mov_b32 s61, 1
  buffer_load_dwordx4 v[64:67], v5, s[16:19], s60 offen sc1
UN_12:
  s_cmp_le_u32 s59, 13
  s_cbranch_scc1 UN_20
  s_cmp_gt_u32 s63, 13
  s_cbranch_scc1 UN_13
  v_and_b32 v14, 1, v71
  v_cmp_ne_u32 vcc, 0, v14
  s_cbranch_vccz UN_13
  s_add_u32 s60, s57, 1703936
  s_mov_b32 s61, 1
  buffer_load_dwordx4 v[68:71], v5, s[16:19], s60 offen sc1
UN_13:
  s_cmp_le_u32 s59, 14
  s_cbranch_scc1 UN_20
  s_cmp_gt_u32 s63, 14
  s_cbranch_scc1 UN_14
  v_cmp_eq_u32 vcc, -1, v115
  s_cbranch_vccz UN_14
  s_add_u32 s60, s54, 0
  s_mov_b32 s61, 1
  buffer_load_dwordx4 v[112:115], v5, s[16:19], s60 offen sc1
UN_14:
  s_cmp_le_u32 s59, 15
  s_cbranch_scc1 UN_20
  s_cmp_gt_u32 s63, 15
  s_cbranch_scc1 UN_15
  v_cmp_eq_u32 vcc, -1, v119
  s_cbranch_vccz UN_15
  s_add_u32 s60, s54, 2048
  s_mov_b32 s61, 1
  buffer_load_dwordx4 v[116:119], v5, s[16:19], s60 offen sc1
UN_15:
  s_cmp_le_u32 s59, 16
  s_cbranch_scc1 UN_20
  s_cmp_gt_u32 s63, 16
  s_cbranch_scc1 UN_16
  v_cmp_eq_u32 vcc, -1, v123
  s_cbranch_vccz UN_16
  s_add_u32 s60, s54, 4096
  s_mov_b32 s61, 1
  buffer_load_dwordx4 v[120:123], v5, s[16:19], s60 offen sc1
UN_16:
  s_cmp_le_u32 s59, 17
  s_cbranch_scc1 UN_20
  s_cmp_gt_u32 s63, 17
  s_cbranch_scc1 UN_17
  v_cmp_eq_u32 vcc, -1, v127
  s_cbranch_vccz UN_17
  s_add_u32 s60, s54, 6144
  s_mov_b32 s61, 1
  buffer_load_dwordx4 v[124:127], v5, s[16:19], s60 offen sc1
UN_17:
  s_cmp_le_u32 s59, 18
  s_cbranch_scc1 UN_20
  s_cmp_gt_u32 s63, 18
  s_cbranch_scc1 UN_18
  v_cmp_eq_u32 vcc, -1, v131
  s_cbranch_vccz UN_18
  s_add_u32 s60, s54, 8192
  s_mov_b32 s61, 1
  buffer_load_dwordx4 v[128:131], v5, s[16:19], s60 offen sc1
UN_18:
  s_cmp_le_u32 s59, 19
  s_cbranch_scc1 UN_20
  s_cmp_gt_u32 s63, 19
  s_cbranch_scc1 UN_19
  v_cmp_eq_u32 vcc, -1, v135
  s_cbranch_vccz UN_19
  s_add_u32 s60, s54, 10240
  s_mov_b32 s61, 1
  buffer_load_dwordx4 v[132:135], v5, s[16:19], s60 offen sc1
UN_19:
  s_cmp_le_u32 s59, 20
  s_cbranch_scc1 UN_20
  s_cmp_gt_u32 s63, 20
  s_cbranch_scc1 UN_20
  v_cmp_eq_u32 vcc, -1, v139
  s_cbranch_vccz UN_20
  s_add_u32 s60, s54, 12288
  s_mov_b32 s61, 1
  buffer_load_dwordx4 v[136:139], v5, s[16:19], s60 offen sc1
UN_20:
  s_cmp_eq_u32 s61, 0
  s_cbranch_scc1 UD
  s_sub_u32 s62, s62, 1
  s_cbranch_scc0 UL
  s_waitcnt vmcnt(0)
UD:
  s_cmp_eq_u32 s63, 0
  s_cbranch_scc1 UR_0
  s_cmp_eq_u32 s63, 1
  s_cbranch_scc1 UR_1
  s_cmp_eq_u32 s63, 2
  s_cbranch_scc1 UR_2
  s_cmp_eq_u32 s63, 3
  s_cbranch_scc1 UR_3
  s_cmp_eq_u32 s63, 4
  s_cbranch_scc1 UR_4
  s_cmp_eq_u32 s63, 5
  s_cbranch_scc1 UR_5
  s_cmp_eq_u32 s63, 6
  s_cbranch_scc1 UR_6
  s_cmp_eq_u32 s63, 7
  s_cbranch_scc1 UR_7
  s_cmp_eq_u32 s63, 8
  s_cbranch_scc1 UR_8
  s_cmp_eq_u32 s63, 9
  s_cbranch_scc1 UR_9
  s_cmp_eq_u32 s63, 10
  s_cbranch_scc1 UR_10
  s_cmp_eq_u32 s63, 11
  s_cbranch_scc1 UR_11
  s_cmp_eq_u32 s63, 12
  s_cbranch_scc1 UR_12
  s_cmp_eq_u32 s63, 13
  s_cbranch_scc1 UR_13
  s_cmp_eq_u32 s63, 14
  s_cbranch_scc1 UR_14
  s_cmp_eq_u32 s63, 15
  s_cbranch_scc1 UR_15
  s_cmp_eq_u32 s63, 16
  s_cbranch_scc1 UR_16
  s_cmp_eq_u32 s63, 17
  s_cbranch_scc1 UR_17
  s_cmp_eq_u32 s63, 18
  s_cbranch_scc1 UR_18
  s_cmp_eq_u32 s63, 19
  s_cbranch_scc1 UR_19
  s_branch UR_20
L_ATT:
  s_sub_u32 s49, s49, 896
  s_lshr_b32 s50, s41, 1
  s_and_b32 s53, s41, 1
  s_mul_i32 s64, s50, 7
  s_and_b32 s51, s64, 3
  s_lshr_b32 s52, s64, 2
  s_lshl_b32 s66, s41, 3
  s_add_u32 s66, s66, s40
  s_mul_i32 s67, s66, 3136
  s_mul_i32 s69, s66, 1568
  s_mul_i32 s55, s66, 4704
  s_mul_i32 s54, s66, 196
  s_mul_i32 s56, s66, 7168
  s_add_u32 s56, s56, 8388608
  s_lshl_b32 s66, s66, 15
  v_add_u32 v6, s54, v0
  s_bfe_u32 s54, s41, 0x10003
  s_lshl_b32 s54, s54, 11
  s_add_u32 s66, s66, s54
  s_add_u32 s57, s46, 155648
  s_mov_b32 s72, 0x0f0f0f0f
  s_mov_b32 s73, 0xf0f0f0f0
  v_lshrrev_b32 v253, 2, v0
  v_lshlrev_b32 v253, 12, v253
  v_and_b32 v252, 3, v0
  v_lshl_add_u32 v253, v252, 7, v253
  s_add_u32 m0, s46, 0
  s_add_u32 s61, s49, 0
  buffer_load_dwordx4 v2, s[8:11], s61 offen lds
  s_add_u32 m0, s46, 8192
  s_add_u32 s61, s49, 128
  buffer_load_dwordx4 v2, s[8:11], s61 offen lds
  s_add_u32 m0, s46, 16384
  s_add_u32 s61, s49, 256
  buffer_load_dwordx4 v2, s[8:11], s61 offen lds
  s_add_u32 m0, s46, 24576
  s_add_u32 s61, s49, 384
  s_mov_b64 exec, s[72:73]
  buffer_load_dwordx4 v2, s[8:11], s61 offen lds
  s_mov_b64 exec, -1
  s_mov_b32 s63, 0x3f803f80
  v_mov_b32 v104, 0
  v_mov_b32 v105, 0
  v_mov_b32 v106, 0
  v_mov_b32 v107, 0
  s_lshl_b32 s64, s45, 5
  s_lshl_b32 s65, s44, 2
  s_add_u32 s64, s64, s65
  v_lshrrev_b32 v6, 5, v0
  v_lshlrev_b32 v6, 4, v6
  v_and_b32 v7, 3, v12
  v_add3_u32 v6, v6, v7, s64
  v_lshlrev_b32 v7, 7, v6
  v_bfe_u32 v6, v6, 1, 3
  v_xor_b32 v6, v6, v13
  v_lshl_add_u32 v7, v6, 4, v7
  v_add_u32 v112, 98304, v7
  v_and_b32 v8, 15, v0
  v_lshrrev_b32 v6, 4, v0
  v_lshrrev_b32 v7, 1, v8
  v_xor_b32 v6, v6, v7
  v_lshlrev_b32 v6, 4, v6
  v_lshl_add_u32 v6, v8, 7, v6
  s_lshl_b32 s64, s45, 12
  s_add_u32 s64, s64, 98304
  v_add_u32 v6, s64, v6
  v_xor_b32 v7, 64, v6
  v_bfe_u32 v9, v0, 2, 3
  v_lshrrev_b32 v10, 5, v0
  v_lshlrev_b32 v10, 11, v10
  v_lshl_add_u32 v10, v9, 7, v10
  v_and_b32 v8, 3, v0
  v_lshl_add_u32 v10, v8, 3, v10
  v_lshrrev_b32 v9, 1, v9
  v_lshlrev_b32 v9, 5, v9
  v_or_b32 v10, v10, v9
  s_mul_i32 s64, s44, 14
  v_and_b32 v13, 3, v0
  v_add_u32 v13, s64, v13
  v_and_b32 v14, 4294967271, v10
  v_add_u32 v1, 0, v13
  v_min_u32 v1, 55, v1
  v_and_b32 v3, 15, v1
  v_lshlrev_b32 v3, 3, v3
  v_xor_b32 v3, v3, v14
  v_lshrrev_b32 v1, 4, v1
  v_lshl_add_u32 v8, v1, 13, v3
  v_add_u32 v1, 4, v13
  v_min_u32 v1, 55, v1
  v_and_b32 v3, 15, v1
  v_lshlrev_b32 v3, 3, v3
  v_xor_b32 v3, v3, v14
  v_lshrrev_b32 v1, 4, v1
  v_lshl_add_u32 v9, v1, 13, v3
  v_add_u32 v1, 7, v13
  v_min_u32 v1, 55, v1
  v_and_b32 v3, 15, v1
  v_lshlrev_b32 v3, 3, v3
  v_xor_b32 v3, v3, v14
  v_lshrrev_b32 v1, 4, v1
  v_lshl_add_u32 v10, v1, 13, v3
  v_add_u32 v1, 11, v13
  v_min_u32 v1, 55, v1
  v_and_b32 v3, 15, v1
  v_lshlrev_b32 v3, 3, v3
  v_xor_b32 v3, v3, v14
  v_lshrrev_b32 v1, 4, v1
  v_lshl_add_u32 v11, v1, 13, v3
  v_add_u32 v1, 0x10000, v8
  v_add_u32 v3, 0x10000, v9
  v_add_u32 v4, 0x10000, v10
  v_add_u32 v12, 0x10000, v11
  v_mov_b32 v248, -1
  v_mov_b32 v249, -1
  v_mov_b32 v250, -1
  v_mov_b32 v251, -1
  s_getpc_b64 s[76:77]
CP_19:
  s_sub_u32 s76, s76, CP_19-parallel_sum__linear_attn_block__mixer_gmlp__prompt_kernel
  s_subb_u32 s77, s77, 0
  s_mov_b32 s78, L_EXIT-parallel_sum__linear_attn_block__mixer_gmlp__prompt_kernel
  s_mov_b32 s79, 0x20000
  s_lshl_b32 s64, s42, 3
  s_add_u32 s64, s64, s40
  s_lshl_b32 s64, s64, 10
  v_and_b32 v13, 15, v0
  v_lshl_add_u32 v13, v13, 6, s64
  v_min_u32 v13, L_EXIT-parallel_sum__linear_attn_block__mixer_gmlp__prompt_kernel-4, v13
  buffer_load_dword v252, v13, s[76:79], 0 offen
  s_waitcnt vmcnt(11)
  v_dot2c_f32_bf16 v104, s63, v16
  v_dot2c_f32_bf16 v106, v16, v16
  v_dot2c_f32_bf16 v105, s63, v17
  v_dot2c_f32_bf16 v107, v17, v17
  v_dot2c_f32_bf16 v104, s63, v18
  v_dot2c_f32_bf16 v106, v18, v18
  v_dot2c_f32_bf16 v105, s63, v19
  v_dot2c_f32_bf16 v107, v19, v19
  v_lshlrev_b32 v48, 16, v16
  v_and_b32 v49, 0xffff0000, v16
  v_lshlrev_b32 v50, 16, v17
  v_and_b32 v51, 0xffff0000, v17
  v_lshlrev_b32 v52, 16, v18
  v_and_b32 v53, 0xffff0000, v18
  v_lshlrev_b32 v54, 16, v19
  v_and_b32 v55, 0xffff0000, v19
  s_waitcnt vmcnt(10)
  v_dot2c_f32_bf16 v104, s63, v20
  v_dot2c_f32_bf16 v106, v20, v20
  v_dot2c_f32_bf16 v105, s63, v21
  v_dot2c_f32_bf16 v107, v21, v21
  v_dot2c_f32_bf16 v104, s63, v22
  v_dot2c_f32_bf16 v106, v22, v22
  v_dot2c_f32_bf16 v105, s63, v23
  v_dot2c_f32_bf16 v107, v23, v23
  v_lshlrev_b32 v56, 16, v20
  v_and_b32 v57, 0xffff0000, v20
  v_lshlrev_b32 v58, 16, v21
  v_and_b32 v59, 0xffff0000, v21
  v_lshlrev_b32 v60, 16, v22
  v_and_b32 v61, 0xffff0000, v22
  v_lshlrev_b32 v62, 16, v23
  v_and_b32 v63, 0xffff0000, v23
  s_waitcnt vmcnt(9)
  v_dot2c_f32_bf16 v104, s63, v24
  v_dot2c_f32_bf16 v106, v24, v24
  v_dot2c_f32_bf16 v105, s63, v25
  v_dot2c_f32_bf16 v107, v25, v25
  v_dot2c_f32_bf16 v104, s63, v26
  v_dot2c_f32_bf16 v106, v26, v26
  v_dot2c_f32_bf16 v105, s63, v27
  v_dot2c_f32_bf16 v107, v27, v27
  v_lshlrev_b32 v64, 16, v24
  v_and_b32 v65, 0xffff0000, v24
  v_lshlrev_b32 v66, 16, v25
  v_and_b32 v67, 0xffff0000, v25
  v_lshlrev_b32 v68, 16, v26
  v_and_b32 v69, 0xffff0000, v26
  v_lshlrev_b32 v70, 16, v27
  v_and_b32 v71, 0xffff0000, v27
  s_add_u32 m0, s46, 32768
  s_add_u32 s61, s49, 172032
  buffer_load_dwordx4 v2, s[8:11], s61 offen lds
  s_waitcnt vmcnt(9)
  v_dot2c_f32_bf16 v104, s63, v28
  v_dot2c_f32_bf16 v106, v28, v28
  v_dot2c_f32_bf16 v105, s63, v29
  v_dot2c_f32_bf16 v107, v29, v29
  v_dot2c_f32_bf16 v104, s63, v30
  v_dot2c_f32_bf16 v106, v30, v30
  v_dot2c_f32_bf16 v105, s63, v31
  v_dot2c_f32_bf16 v107, v31, v31
  v_lshlrev_b32 v72, 16, v28
  v_and_b32 v73, 0xffff0000, v28
  v_lshlrev_b32 v74, 16, v29
  v_and_b32 v75, 0xffff0000, v29
  v_lshlrev_b32 v76, 16, v30
  v_and_b32 v77, 0xffff0000, v30
  v_lshlrev_b32 v78, 16, v31
  v_and_b32 v79, 0xffff0000, v31
  s_add_u32 m0, s46, 40960
  s_add_u32 s61, s49, 172160
  buffer_load_dwordx4 v2, s[8:11], s61 offen lds
  s_waitcnt vmcnt(9)
  v_dot2c_f32_bf16 v104, s63, v32
  v_dot2c_f32_bf16 v106, v32, v32
  v_dot2c_f32_bf16 v105, s63, v33
  v_dot2c_f32_bf16 v107, v33, v33
  v_dot2c_f32_bf16 v104, s63, v34
  v_dot2c_f32_bf16 v106, v34, v34
  v_dot2c_f32_bf16 v105, s63, v35
  v_dot2c_f32_bf16 v107, v35, v35
  v_lshlrev_b32 v80, 16, v32
  v_and_b32 v81, 0xffff0000, v32
  v_lshlrev_b32 v82, 16, v33
  v_and_b32 v83, 0xffff0000, v33
  v_lshlrev_b32 v84, 16, v34
  v_and_b32 v85, 0xffff0000, v34
  v_lshlrev_b32 v86, 16, v35
  v_and_b32 v87, 0xffff0000, v35
  s_add_u32 m0, s46, 49152
  s_add_u32 s61, s49, 172288
  buffer_load_dwordx4 v2, s[8:11], s61 offen lds
  s_waitcnt vmcnt(9)
  v_dot2c_f32_bf16 v104, s63, v36
  v_dot2c_f32_bf16 v106, v36, v36
  v_dot2c_f32_bf16 v105, s63, v37
  v_dot2c_f32_bf16 v107, v37, v37
  v_dot2c_f32_bf16 v104, s63, v38
  v_dot2c_f32_bf16 v106, v38, v38
  v_dot2c_f32_bf16 v105, s63, v39
  v_dot2c_f32_bf16 v107, v39, v39
  v_lshlrev_b32 v88, 16, v36
  v_and_b32 v89, 0xffff0000, v36
  v_lshlrev_b32 v90, 16, v37
  v_and_b32 v91, 0xffff0000, v37
  v_lshlrev_b32 v92, 16, v38
  v_and_b32 v93, 0xffff0000, v38
  v_lshlrev_b32 v94, 16, v39
  v_and_b32 v95, 0xffff0000, v39
  s_add_u32 m0, s46, 57344
  s_add_u32 s61, s49, 172416
  s_mov_b64 exec, s[72:73]
  buffer_load_dwordx4 v2, s[8:11], s61 offen lds
  s_mov_b64 exec, -1
  s_waitcnt vmcnt(9)
  v_dot2c_f32_bf16 v104, s63, v40
  v_dot2c_f32_bf16 v106, v40, v40
  v_dot2c_f32_bf16 v105, s63, v41
  v_dot2c_f32_bf16 v107, v41, v41
  v_dot2c_f32_bf16 v104, s63, v42
  v_dot2c_f32_bf16 v106, v42, v42
  v_dot2c_f32_bf16 v105, s63, v43
  v_dot2c_f32_bf16 v107, v43, v43
  s_add_u32 m0, s46, 65536
  s_add_u32 s61, s49, 344064
  buffer_load_dwordx4 v2, s[8:11], s61 offen lds
  v_lshlrev_b32 v96, 16, v40
  v_and_b32 v97, 0xffff0000, v40
  v_add_f32 v104, v104, v105
  v_add_f32 v106, v106, v107
  v_lshlrev_b32 v98, 16, v41
  v_add_f32_dpp v104, v104, v104 quad_perm:[1,0,3,2] row_mask:0xf bank_mask:0xf
  v_add_f32_dpp v106, v106, v106 quad_perm:[1,0,3,2] row_mask:0xf bank_mask:0xf
  v_and_b32 v99, 0xffff0000, v41
  v_add_f32_dpp v104, v104, v104 quad_perm:[2,3,0,1] row_mask:0xf bank_mask:0xf
  v_add_f32_dpp v106, v106, v106 quad_perm:[2,3,0,1] row_mask:0xf bank_mask:0xf
  v_lshlrev_b32 v100, 16, v42
  v_add_f32_dpp v104, v104, v104 row_half_mirror row_mask:0xf bank_mask:0xf
  v_add_f32_dpp v106, v106, v106 row_half_mirror row_mask:0xf bank_mask:0xf
  v_mul_f32 v104, 0x3b124925, v104
  v_mul_f32 v106, 0x3b124925, v106
  v_fma_f32 v106, -v104, v104, v106
  v_max_f32 v106, 0, v106
  v_add_f32 v106, 0x3727c5ac, v106
  v_rsq_f32 v108, v106
  v_and_b32 v101, 0xffff0000, v42
  v_lshlrev_b32 v102, 16, v43
  v_and_b32 v103, 0xffff0000, v43
  v_mul_f32 v110, -v104, v108
  v_mov_b32 v109, v108
  v_mov_b32 v111, v110
  v_pk_fma_f32 v[48:49], v[48:49], v[108:109], v[110:111]
  v_pk_fma_f32 v[50:51], v[50:51], v[108:109], v[110:111]
  v_pk_fma_f32 v[52:53], v[52:53], v[108:109], v[110:111]
  v_pk_fma_f32 v[54:55], v[54:55], v[108:109], v[110:111]
  v_cvt_pk_bf16_f32 v16, v48, v49
  v_cvt_pk_bf16_f32 v17, v50, v51
  v_cvt_pk_bf16_f32 v18, v52, v53
  v_cvt_pk_bf16_f32 v19, v54, v55
  ds_write_b128 v112, v[16:19] offset:0
  s_add_u32 m0, s46, 73728
  s_add_u32 s61, s49, 344192
  buffer_load_dwordx4 v2, s[8:11], s61 offen lds
  v_pk_fma_f32 v[56:57], v[56:57], v[108:109], v[110:111]
  v_pk_fma_f32 v[58:59], v[58:59], v[108:109], v[110:111]
  v_pk_fma_f32 v[60:61], v[60:61], v[108:109], v[110:111]
  v_pk_fma_f32 v[62:63], v[62:63], v[108:109], v[110:111]
  v_cvt_pk_bf16_f32 v20, v56, v57
  v_cvt_pk_bf16_f32 v21, v58, v59
  v_cvt_pk_bf16_f32 v22, v60, v61
  v_cvt_pk_bf16_f32 v23, v62, v63
  ds_write_b128 v112, v[20:23] offset:8192
  s_add_u32 m0, s46, 81920
  s_add_u32 s61, s49, 344320
  buffer_load_dwordx4 v2, s[8:11], s61 offen lds
  v_pk_fma_f32 v[64:65], v[64:65], v[108:109], v[110:111]
  v_pk_fma_f32 v[66:67], v[66:67], v[108:109], v[110:111]
  v_pk_fma_f32 v[68:69], v[68:69], v[108:109], v[110:111]
  v_pk_fma_f32 v[70:71], v[70:71], v[108:109], v[110:111]
  v_cvt_pk_bf16_f32 v24, v64, v65
  v_cvt_pk_bf16_f32 v25, v66, v67
  v_cvt_pk_bf16_f32 v26, v68, v69
  v_cvt_pk_bf16_f32 v27, v70, v71
  ds_write_b128 v112, v[24:27] offset:16384
  s_add_u32 m0, s46, 90112
  s_add_u32 s61, s49, 344448
  s_mov_b64 exec, s[72:73]
  buffer_load_dwordx4 v2, s[8:11], s61 offen lds
  s_mov_b64 exec, -1
  v_pk_fma_f32 v[72:73], v[72:73], v[108:109], v[110:111]
  v_pk_fma_f32 v[74:75], v[74:75], v[108:109], v[110:111]
  v_pk_fma_f32 v[76:77], v[76:77], v[108:109], v[110:111]
  v_pk_fma_f32 v[78:79], v[78:79], v[108:109], v[110:111]
  v_cvt_pk_bf16_f32 v28, v72, v73
  v_cvt_pk_bf16_f32 v29, v74, v75
  v_cvt_pk_bf16_f32 v30, v76, v77
  v_cvt_pk_bf16_f32 v31, v78, v79
  ds_write_b128 v112, v[28:31] offset:24576
  v_pk_fma_f32 v[80:81], v[80:81], v[108:109], v[110:111]
  v_pk_fma_f32 v[82:83], v[82:83], v[108:109], v[110:111]
  v_pk_fma_f32 v[84:85], v[84:85], v[108:109], v[110:111]
  v_pk_fma_f32 v[86:87], v[86:87], v[108:109], v[110:111]
  v_cvt_pk_bf16_f32 v32, v80, v81
  v_cvt_pk_bf16_f32 v33, v82, v83
  v_cvt_pk_bf16_f32 v34, v84, v85
  v_cvt_pk_bf16_f32 v35, v86, v87
  ds_write_b128 v112, v[32:35] offset:32768
  v_pk_fma_f32 v[88:89], v[88:89], v[108:109], v[110:111]
  v_pk_fma_f32 v[90:91], v[90:91], v[108:109], v[110:111]
  v_pk_fma_f32 v[92:93], v[92:93], v[108:109], v[110:111]
  v_pk_fma_f32 v[94:95], v[94:95], v[108:109], v[110:111]
  v_cvt_pk_bf16_f32 v36, v88, v89
  v_cvt_pk_bf16_f32 v37, v90, v91
  v_cvt_pk_bf16_f32 v38, v92, v93
  v_cvt_pk_bf16_f32 v39, v94, v95
  ds_write_b128 v112, v[36:39] offset:40960
  v_pk_fma_f32 v[96:97], v[96:97], v[108:109], v[110:111]
  v_pk_fma_f32 v[98:99], v[98:99], v[108:109], v[110:111]
  v_pk_fma_f32 v[100:101], v[100:101], v[108:109], v[110:111]
  v_pk_fma_f32 v[102:103], v[102:103], v[108:109], v[110:111]
  v_cvt_pk_bf16_f32 v40, v96, v97
  v_cvt_pk_bf16_f32 v41, v98, v99
  v_cvt_pk_bf16_f32 v42, v100, v101
  v_cvt_pk_bf16_f32 v43, v102, v103
  ds_write_b128 v112, v[40:43] offset:49152
  s_lshl_b32 s64, s2, 3
  s_add_u32 s64, s64, s40
  s_lshr_b32 s65, s64, 2
  s_min_u32 s65, s65, 447
  s_mul_i32 s65, s65, 3584
  s_and_b32 s62, s64, 3
  s_lshl_b32 s62, s62, 2
  v_min_u32 v13, 3, v0
  v_add_u32 v13, s62, v13
  v_min_u32 v13, 13, v13
  v_lshlrev_b32 v13, 7, v13
  buffer_load_dword v252, v13, s[12:15], s65 offen offset:0
  s_lshl_b32 s64, s2, 3
  s_add_u32 s64, s64, s40
  s_mul_i32 s62, s64, 392
  s_mul_i32 s65, s64, 196
  v_lshlrev_b32 v13, 6, v0
  v_min_u32 v13, 384, v13
  buffer_load_dword v252, v13, s[32:35], s62 offen
  v_min_u32 v13, 192, v13
  buffer_load_dword v252, v13, s[28:31], s65 offen
  s_min_u32 s64, s40, 2
  s_mul_i32 s58, s50, 3
  s_add_u32 s58, s58, s64
  s_lshl_b32 s58, s58, 10
  s_lshl_b32 s64, s53, 3
  s_add_u32 s58, s58, s64
  s_add_u32 s58, s58, 294912
  buffer_store_dwordx2 v[248:249], v5, s[16:19], s58 offen sc1
  s_waitcnt vmcnt(8) lgkmcnt(0)
  s_add_u32 s43, s43, 2654435769
  s_xor_b32 s100, s100, s43
  s_barrier
  ds_read_b128 v[16:19], v6 offset:0
  ds_read_b128 v[20:23], v6 offset:2048
  ds_read_b128 v[24:27], v7 offset:0
  ds_read_b128 v[28:31], v7 offset:2048
  ds_read_b64_tr_b16 v[128:129], v8 offset:0
  ds_read_b64_tr_b16 v[130:131], v8 offset:1024
  ds_read_b64_tr_b16 v[132:133], v9 offset:0
  ds_read_b64_tr_b16 v[134:135], v9 offset:1024
  ds_read_b64_tr_b16 v[136:137], v10 offset:0
  ds_read_b64_tr_b16 v[138:139], v10 offset:1024
  ds_read_b64_tr_b16 v[140:141], v11 offset:0
  ds_read_b64_tr_b16 v[142:143], v11 offset:1024
  ds_read_b64_tr_b16 v[144:145], v8 offset:4096
  ds_read_b64_tr_b16 v[146:147], v8 offset:5120
  ds_read_b64_tr_b16 v[148:149], v9 offset:4096
  ds_read_b64_tr_b16 v[150:151], v9 offset:5120
  ds_read_b64_tr_b16 v[152:153], v10 offset:4096
  ds_read_b64_tr_b16 v[154:155], v10 offset:5120
  ds_read_b64_tr_b16 v[156:157], v11 offset:4096
  ds_read_b64_tr_b16 v[158:159], v11 offset:5120
  s_waitcnt lgkmcnt(0)
  v_mfma_f32_16x16x32_bf16 v[192:195], v[128:131], v[16:19], 0
  ds_read_b64_tr_b16 v[160:161], v8 offset:32768
  ds_read_b64_tr_b16 v[162:163], v8 offset:33792
  ds_read_b64_tr_b16 v[164:165], v9 offset:32768
  ds_read_b64_tr_b16 v[166:167], v9 offset:33792
  v_mfma_f32_16x16x32_bf16 v[208:211], v[128:131], v[20:23], 0
  ds_read_b64_tr_b16 v[168:169], v10 offset:32768
  ds_read_b64_tr_b16 v[170:171], v10 offset:33792
  ds_read_b64_tr_b16 v[172:173], v11 offset:32768
  ds_read_b64_tr_b16 v[174:175], v11 offset:33792
  v_mfma_f32_16x16x32_bf16 v[196:199], v[132:135], v[16:19], 0
  ds_read_b64_tr_b16 v[176:177], v8 offset:36864
  ds_read_b64_tr_b16 v[178:179], v8 offset:37888
  ds_read_b64_tr_b16 v[180:181], v9 offset:36864
  v_mfma_f32_16x16x32_bf16 v[212:215], v[132:135], v[20:23], 0
  ds_read_b64_tr_b16 v[182:183], v9 offset:37888
  ds_read_b64_tr_b16 v[184:185], v10 offset:36864
  ds_read_b64_tr_b16 v[186:187], v10 offset:37888
  v_mfma_f32_16x16x32_bf16 v[200:203], v[136:139], v[16:19], 0
  ds_read_b64_tr_b16 v[188:189], v11 offset:36864
  ds_read_b64_tr_b16 v[190:191], v11 offset:37888
  ds_read_b128 v[32:35], v6 offset:8192
  v_mfma_f32_16x16x32_bf16 v[216:219], v[136:139], v[20:23], 0
  ds_read_b128 v[36:39], v6 offset:10240
  ds_read_b128 v[40:43], v7 offset:8192
  ds_read_b128 v[44:47], v7 offset:10240
  v_mfma_f32_16x16x32_bf16 v[204:207], v[140:143], v[16:19], 0
  v_mfma_f32_16x16x32_bf16 v[220:223], v[140:143], v[20:23], 0
  v_mfma_f32_16x16x32_bf16 v[192:195], v[144:147], v[24:27], v[192:195]
  v_mfma_f32_16x16x32_bf16 v[208:211], v[144:147], v[28:31], v[208:211]
  v_mfma_f32_16x16x32_bf16 v[196:199], v[148:151], v[24:27], v[196:199]
  v_mfma_f32_16x16x32_bf16 v[212:215], v[148:151], v[28:31], v[212:215]
  v_mfma_f32_16x16x32_bf16 v[200:203], v[152:155], v[24:27], v[200:203]
  v_mfma_f32_16x16x32_bf16 v[216:219], v[152:155], v[28:31], v[216:219]
  v_mfma_f32_16x16x32_bf16 v[204:207], v[156:159], v[24:27], v[204:207]
  v_mfma_f32_16x16x32_bf16 v[220:223], v[156:159], v[28:31], v[220:223]
  s_waitcnt vmcnt(4) lgkmcnt(0)
  s_barrier
  v_mfma_f32_16x16x32_bf16 v[192:195], v[160:163], v[32:35], v[192:195]
  ds_read_b64_tr_b16 v[128:129], v1 offset:0
  ds_read_b64_tr_b16 v[130:131], v1 offset:1024
  ds_read_b64_tr_b16 v[132:133], v3 offset:0
  ds_read_b64_tr_b16 v[134:135], v3 offset:1024
  v_mfma_f32_16x16x32_bf16 v[208:211], v[160:163], v[36:39], v[208:211]
  ds_read_b64_tr_b16 v[136:137], v4 offset:0
  ds_read_b64_tr_b16 v[138:139], v4 offset:1024
  ds_read_b64_tr_b16 v[140:141], v12 offset:0
  ds_read_b64_tr_b16 v[142:143], v12 offset:1024
  v_mfma_f32_16x16x32_bf16 v[196:199], v[164:167], v[32:35], v[196:199]
  ds_read_b64_tr_b16 v[144:145], v1 offset:4096
  ds_read_b64_tr_b16 v[146:147], v1 offset:5120
  ds_read_b64_tr_b16 v[148:149], v3 offset:4096
  v_mfma_f32_16x16x32_bf16 v[212:215], v[164:167], v[36:39], v[212:215]
  ds_read_b64_tr_b16 v[150:151], v3 offset:5120
  ds_read_b64_tr_b16 v[152:153], v4 offset:4096
  ds_read_b64_tr_b16 v[154:155], v4 offset:5120
  v_mfma_f32_16x16x32_bf16 v[200:203], v[168:171], v[32:35], v[200:203]
  ds_read_b64_tr_b16 v[156:157], v12 offset:4096
  ds_read_b64_tr_b16 v[158:159], v12 offset:5120
  ds_read_b128 v[48:51], v6 offset:16384
  v_mfma_f32_16x16x32_bf16 v[216:219], v[168:171], v[36:39], v[216:219]
  ds_read_b128 v[52:55], v6 offset:18432
  ds_read_b128 v[56:59], v7 offset:16384
  ds_read_b128 v[60:63], v7 offset:18432
  v_mfma_f32_16x16x32_bf16 v[204:207], v[172:175], v[32:35], v[204:207]
  s_add_u32 m0, s46, 0
  s_add_u32 s61, s49, 516096
  buffer_load_dwordx4 v2, s[8:11], s61 offen lds
  v_mfma_f32_16x16x32_bf16 v[220:223], v[172:175], v[36:39], v[220:223]
  s_add_u32 m0, s46, 8192
  s_add_u32 s61, s49, 516224
  buffer_load_dwordx4 v2, s[8:11], s61 offen lds
  v_mfma_f32_16x16x32_bf16 v[192:195], v[176:179], v[40:43], v[192:195]
  s_add_u32 m0, s46, 16384
  s_add_u32 s61, s49, 516352
  buffer_load_dwordx4 v2, s[8:11], s61 offen lds
  v_mfma_f32_16x16x32_bf16 v[208:211], v[176:179], v[44:47], v[208:211]
  s_add_u32 m0, s46, 24576
  s_add_u32 s61, s49, 516480
  s_mov_b64 exec, s[72:73]
  buffer_load_dwordx4 v2, s[8:11], s61 offen lds
  s_mov_b64 exec, -1
  v_mfma_f32_16x16x32_bf16 v[196:199], v[180:183], v[40:43], v[196:199]
  s_add_u32 m0, s46, 32768
  s_add_u32 s61, s49, 688128
  buffer_load_dwordx4 v2, s[8:11], s61 offen lds
  v_mfma_f32_16x16x32_bf16 v[212:215], v[180:183], v[44:47], v[212:215]
  s_add_u32 m0, s46, 40960
  s_add_u32 s61, s49, 688256
  buffer_load_dwordx4 v2, s[8:11], s61 offen lds
  v_mfma_f32_16x16x32_bf16 v[200:203], v[184:187], v[40:43], v[200:203]
  s_add_u32 m0, s46, 49152
  s_add_u32 s61, s49, 688384
  buffer_load_dwordx4 v2, s[8:11], s61 offen lds
  v_mfma_f32_16x16x32_bf16 v[216:219], v[184:187], v[44:47], v[216:219]
  s_add_u32 m0, s46, 57344
  s_add_u32 s61, s49, 688512
  s_mov_b64 exec, s[72:73]
  buffer_load_dwordx4 v2, s[8:11], s61 offen lds
  s_mov_b64 exec, -1
  v_mfma_f32_16x16x32_bf16 v[204:207], v[188:191], v[40:43], v[204:207]
  v_mfma_f32_16x16x32_bf16 v[220:223], v[188:191], v[44:47], v[220:223]
  s_waitcnt vmcnt(4) lgkmcnt(0)
  s_barrier
  s_cmp_lg_u32 s40, 2
  s_cbranch_scc1 OW_20
  s_lshl_b32 s64, s42, 5
  s_add_u32 s64, s64, s41
  s_lshl_b32 s64, s64, 7
  s_add_u32 s64, s64, 32768
  s_mov_b64 exec, 1
  v_mov_b32 v14, s43
  buffer_store_dword v14, off, s[16:19], s64 sc1
  s_mov_b64 exec, -1
  s_nop 4
OW_20:
  v_mfma_f32_16x16x32_bf16 v[192:195], v[128:131], v[48:51], v[192:195]
  ds_read_b64_tr_b16 v[160:161], v8 offset:0
  ds_read_b64_tr_b16 v[162:163], v8 offset:1024
  ds_read_b64_tr_b16 v[164:165], v9 offset:0
  ds_read_b64_tr_b16 v[166:167], v9 offset:1024
  v_mfma_f32_16x16x32_bf16 v[208:211], v[128:131], v[52:55], v[208:211]
  ds_read_b64_tr_b16 v[168:169], v10 offset:0
  ds_read_b64_tr_b16 v[170:171], v10 offset:1024
  ds_read_b64_tr_b16 v[172:173], v11 offset:0
  ds_read_b64_tr_b16 v[174:175], v11 offset:1024
  v_mfma_f32_16x16x32_bf16 v[196:199], v[132:135], v[48:51], v[196:199]
  ds_read_b64_tr_b16 v[176:177], v8 offset:4096
  ds_read_b64_tr_b16 v[178:179], v8 offset:5120
  ds_read_b64_tr_b16 v[180:181], v9 offset:4096
  v_mfma_f32_16x16x32_bf16 v[212:215], v[132:135], v[52:55], v[212:215]
  ds_read_b64_tr_b16 v[182:183], v9 offset:5120
  ds_read_b64_tr_b16 v[184:185], v10 offset:4096
  ds_read_b64_tr_b16 v[186:187], v10 offset:5120
  v_mfma_f32_16x16x32_bf16 v[200:203], v[136:139], v[48:51], v[200:203]
  ds_read_b64_tr_b16 v[188:189], v11 offset:4096
  ds_read_b64_tr_b16 v[190:191], v11 offset:5120
  ds_read_b128 v[64:67], v6 offset:24576
  v_mfma_f32_16x16x32_bf16 v[216:219], v[136:139], v[52:55], v[216:219]
  ds_read_b128 v[68:71], v6 offset:26624
  ds_read_b128 v[72:75], v7 offset:24576
  ds_read_b128 v[76:79], v7 offset:26624
  v_mfma_f32_16x16x32_bf16 v[204:207], v[140:143], v[48:51], v[204:207]
  s_add_u32 m0, s46, 65536
  s_add_u32 s61, s49, 860160
  buffer_load_dwordx4 v2, s[8:11], s61 offen lds
  v_mfma_f32_16x16x32_bf16 v[220:223], v[140:143], v[52:55], v[220:223]
  s_add_u32 m0, s46, 73728
  s_add_u32 s61, s49, 860288
  buffer_load_dwordx4 v2, s[8:11], s61 offen lds
  v_mfma_f32_16x16x32_bf16 v[192:195], v[144:147], v[56:59], v[192:195]
  s_add_u32 m0, s46, 81920
  s_add_u32 s61, s49, 860416
  buffer_load_dwordx4 v2, s[8:11], s61 offen lds
  v_mfma_f32_16x16x32_bf16 v[208:211], v[144:147], v[60:63], v[208:211]
  s_add_u32 m0, s46, 90112
  s_add_u32 s61, s49, 860544
  s_mov_b64 exec, s[72:73]
  buffer_load_dwordx4 v2, s[8:11], s61 offen lds
  s_mov_b64 exec, -1
  v_mfma_f32_16x16x32_bf16 v[196:199], v[148:151], v[56:59], v[196:199]
  v_mfma_f32_16x16x32_bf16 v[212:215], v[148:151], v[60:63], v[212:215]
  v_mfma_f32_16x16x32_bf16 v[200:203], v[152:155], v[56:59], v[200:203]
  v_mfma_f32_16x16x32_bf16 v[216:219], v[152:155], v[60:63], v[216:219]
  v_mfma_f32_16x16x32_bf16 v[204:207], v[156:159], v[56:59], v[204:207]
  v_mfma_f32_16x16x32_bf16 v[220:223], v[156:159], v[60:63], v[220:223]
  s_waitcnt vmcnt(4) lgkmcnt(0)
  s_barrier
  v_mfma_f32_16x16x32_bf16 v[192:195], v[160:163], v[64:67], v[192:195]
  ds_read_b64_tr_b16 v[128:129], v8 offset:32768
  ds_read_b64_tr_b16 v[130:131], v8 offset:33792
  ds_read_b64_tr_b16 v[132:133], v9 offset:32768
  ds_read_b64_tr_b16 v[134:135], v9 offset:33792
  v_mfma_f32_16x16x32_bf16 v[208:211], v[160:163], v[68:71], v[208:211]
  ds_read_b64_tr_b16 v[136:137], v10 offset:32768
  ds_read_b64_tr_b16 v[138:139], v10 offset:33792
  ds_read_b64_tr_b16 v[140:141], v11 offset:32768
  ds_read_b64_tr_b16 v[142:143], v11 offset:33792
  v_mfma_f32_16x16x32_bf16 v[196:199], v[164:167], v[64:67], v[196:199]
  ds_read_b64_tr_b16 v[144:145], v8 offset:36864
  ds_read_b64_tr_b16 v[146:147], v8 offset:37888
  ds_read_b64_tr_b16 v[148:149], v9 offset:36864
  v_mfma_f32_16x16x32_bf16 v[212:215], v[164:167], v[68:71], v[212:215]
  ds_read_b64_tr_b16 v[150:151], v9 offset:37888
  ds_read_b64_tr_b16 v[152:153], v10 offset:36864
  ds_read_b64_tr_b16 v[154:155], v10 offset:37888
  v_mfma_f32_16x16x32_bf16 v[200:203], v[168:171], v[64:67], v[200:203]
  ds_read_b64_tr_b16 v[156:157], v11 offset:36864
  ds_read_b64_tr_b16 v[158:159], v11 offset:37888
  ds_read_b128 v[80:83], v6 offset:32768
  v_mfma_f32_16x16x32_bf16 v[216:219], v[168:171], v[68:71], v[216:219]
  ds_read_b128 v[84:87], v6 offset:34816
  ds_read_b128 v[88:91], v7 offset:32768
  ds_read_b128 v[92:95], v7 offset:34816
  v_mfma_f32_16x16x32_bf16 v[204:207], v[172:175], v[64:67], v[204:207]
  s_add_u32 m0, s46, 0
  s_add_u32 s61, s49, 1032192
  buffer_load_dwordx4 v2, s[8:11], s61 offen lds
  v_mfma_f32_16x16x32_bf16 v[220:223], v[172:175], v[68:71], v[220:223]
  s_add_u32 m0, s46, 8192
  s_add_u32 s61, s49, 1032320
  buffer_load_dwordx4 v2, s[8:11], s61 offen lds
  v_mfma_f32_16x16x32_bf16 v[192:195], v[176:179], v[72:75], v[192:195]
  s_add_u32 m0, s46, 16384
  s_add_u32 s61, s49, 1032448
  buffer_load_dwordx4 v2, s[8:11], s61 offen lds
  v_mfma_f32_16x16x32_bf16 v[208:211], v[176:179], v[76:79], v[208:211]
  s_add_u32 m0, s46, 24576
  s_add_u32 s61, s49, 1032576
  s_mov_b64 exec, s[72:73]
  buffer_load_dwordx4 v2, s[8:11], s61 offen lds
  s_mov_b64 exec, -1
  v_mfma_f32_16x16x32_bf16 v[196:199], v[180:183], v[72:75], v[196:199]
  s_add_u32 m0, s46, 98304
  s_add_u32 s61, s49, 448
  buffer_load_dwordx4 v2, s[8:11], s61 offen lds
  v_mfma_f32_16x16x32_bf16 v[212:215], v[180:183], v[76:79], v[212:215]
  s_add_u32 m0, s46, 106496
  s_add_u32 s61, s49, 576
  buffer_load_dwordx4 v2, s[8:11], s61 offen lds
  v_mfma_f32_16x16x32_bf16 v[200:203], v[184:187], v[72:75], v[200:203]
  s_add_u32 m0, s46, 114688
  s_add_u32 s61, s49, 704
  buffer_load_dwordx4 v2, s[8:11], s61 offen lds
  v_mfma_f32_16x16x32_bf16 v[216:219], v[184:187], v[76:79], v[216:219]
  s_add_u32 m0, s46, 122880
  s_add_u32 s61, s49, 832
  s_mov_b64 exec, s[72:73]
  buffer_load_dwordx4 v2, s[8:11], s61 offen lds
  s_mov_b64 exec, -1
  v_mfma_f32_16x16x32_bf16 v[204:207], v[188:191], v[72:75], v[204:207]
  v_mfma_f32_16x16x32_bf16 v[220:223], v[188:191], v[76:79], v[220:223]
  s_waitcnt vmcnt(8) lgkmcnt(0)
  s_barrier
  v_mfma_f32_16x16x32_bf16 v[192:195], v[128:131], v[80:83], v[192:195]
  ds_read_b64_tr_b16 v[160:161], v1 offset:0
  ds_read_b64_tr_b16 v[162:163], v1 offset:1024
  ds_read_b64_tr_b16 v[164:165], v3 offset:0
  ds_read_b64_tr_b16 v[166:167], v3 offset:1024
  v_mfma_f32_16x16x32_bf16 v[208:211], v[128:131], v[84:87], v[208:211]
  ds_read_b64_tr_b16 v[168:169], v4 offset:0
  ds_read_b64_tr_b16 v[170:171], v4 offset:1024
  ds_read_b64_tr_b16 v[172:173], v12 offset:0
  ds_read_b64_tr_b16 v[174:175], v12 offset:1024
  v_mfma_f32_16x16x32_bf16 v[196:199], v[132:135], v[80:83], v[196:199]
  ds_read_b64_tr_b16 v[176:177], v1 offset:4096
  ds_read_b64_tr_b16 v[178:179], v1 offset:5120
  ds_read_b64_tr_b16 v[180:181], v3 offset:4096
  v_mfma_f32_16x16x32_bf16 v[212:215], v[132:135], v[84:87], v[212:215]
  ds_read_b64_tr_b16 v[182:183], v3 offset:5120
  ds_read_b64_tr_b16 v[184:185], v4 offset:4096
  ds_read_b64_tr_b16 v[186:187], v4 offset:5120
  v_mfma_f32_16x16x32_bf16 v[200:203], v[136:139], v[80:83], v[200:203]
  ds_read_b64_tr_b16 v[188:189], v12 offset:4096
  ds_read_b64_tr_b16 v[190:191], v12 offset:5120
  ds_read_b128 v[96:99], v6 offset:40960
  v_mfma_f32_16x16x32_bf16 v[216:219], v[136:139], v[84:87], v[216:219]
  ds_read_b128 v[100:103], v6 offset:43008
  ds_read_b128 v[104:107], v7 offset:40960
  ds_read_b128 v[108:111], v7 offset:43008
  v_mfma_f32_16x16x32_bf16 v[204:207], v[140:143], v[80:83], v[204:207]
  s_add_u32 m0, s46, 32768
  s_add_u32 s61, s49, 172480
  buffer_load_dwordx4 v2, s[8:11], s61 offen lds
  v_mfma_f32_16x16x32_bf16 v[220:223], v[140:143], v[84:87], v[220:223]
  s_add_u32 m0, s46, 40960
  s_add_u32 s61, s49, 172608
  buffer_load_dwordx4 v2, s[8:11], s61 offen lds
  v_mfma_f32_16x16x32_bf16 v[192:195], v[144:147], v[88:91], v[192:195]
  s_add_u32 m0, s46, 49152
  s_add_u32 s61, s49, 172736
  buffer_load_dwordx4 v2, s[8:11], s61 offen lds
  v_mfma_f32_16x16x32_bf16 v[208:211], v[144:147], v[92:95], v[208:211]
  s_add_u32 m0, s46, 57344
  s_add_u32 s61, s49, 172864
  s_mov_b64 exec, s[72:73]
  buffer_load_dwordx4 v2, s[8:11], s61 offen lds
  s_mov_b64 exec, -1
  v_mfma_f32_16x16x32_bf16 v[196:199], v[148:151], v[88:91], v[196:199]
  s_lshl_b32 s64, s45, 3
  s_xor_b32 s64, s64, s41
  s_lshl_b32 s64, s64, 2
  s_add_u32 s64, s64, s44
  s_lshl_b32 s64, s64, 16
  s_bfe_u32 s65, s41, 65539
  s_lshl_b32 s65, s65, 11
  s_add_u32 s64, s64, s65
  s_lshl_b32 s65, s42, 13
  s_add_u32 s62, s64, s65
  v_lshrrev_b32 v13, 5, v0
  v_lshlrev_b32 v13, 12, v13
  v_and_b32 v252, 30, v0
  v_lshl_add_u32 v13, v252, 6, v13
  buffer_load_dword v252, v13, s[20:23], s62 offen
  v_mfma_f32_16x16x32_bf16 v[212:215], v[148:151], v[92:95], v[212:215]
  v_mfma_f32_16x16x32_bf16 v[200:203], v[152:155], v[88:91], v[200:203]
  v_mfma_f32_16x16x32_bf16 v[216:219], v[152:155], v[92:95], v[216:219]
  v_mfma_f32_16x16x32_bf16 v[204:207], v[156:159], v[88:91], v[204:207]
  v_mfma_f32_16x16x32_bf16 v[220:223], v[156:159], v[92:95], v[220:223]
  s_waitcnt vmcnt(9) lgkmcnt(0)
  s_barrier
  v_mfma_f32_16x16x32_bf16 v[192:195], v[160:163], v[96:99], v[192:195]
  ds_read_b64_tr_b16 v[128:129], v8 offset:0
  ds_read_b64_tr_b16 v[130:131], v8 offset:1024
  ds_read_b64_tr_b16 v[132:133], v9 offset:0
  ds_read_b64_tr_b16 v[134:135], v9 offset:1024
  v_mfma_f32_16x16x32_bf16 v[208:211], v[160:163], v[100:103], v[208:211]
  ds_read_b64_tr_b16 v[136:137], v10 offset:0
  ds_read_b64_tr_b16 v[138:139], v10 offset:1024
  ds_read_b64_tr_b16 v[140:141], v11 offset:0
  ds_read_b64_tr_b16 v[142:143], v11 offset:1024
  v_mfma_f32_16x16x32_bf16 v[196:199], v[164:167], v[96:99], v[196:199]
  ds_read_b64_tr_b16 v[144:145], v8 offset:4096
  ds_read_b64_tr_b16 v[146:147], v8 offset:5120
  ds_read_b64_tr_b16 v[148:149], v9 offset:4096
  v_mfma_f32_16x16x32_bf16 v[212:215], v[164:167], v[100:103], v[212:215]
  ds_read_b64_tr_b16 v[150:151], v9 offset:5120
  ds_read_b64_tr_b16 v[152:153], v10 offset:4096
  ds_read_b64_tr_b16 v[154:155], v10 offset:5120
  v_mfma_f32_16x16x32_bf16 v[200:203], v[168:171], v[96:99], v[200:203]
  ds_read_b64_tr_b16 v[156:157], v11 offset:4096
  ds_read_b64_tr_b16 v[158:159], v11 offset:5120
  ds_read_b128 v[112:115], v6 offset:49152
  v_mfma_f32_16x16x32_bf16 v[216:219], v[168:171], v[100:103], v[216:219]
  ds_read_b128 v[116:119], v6 offset:51200
  ds_read_b128 v[120:123], v7 offset:49152
  ds_read_b128 v[124:127], v7 offset:51200
  v_mfma_f32_16x16x32_bf16 v[204:207], v[172:175], v[96:99], v[204:207]
  s_add_u32 m0, s46, 65536
  s_add_u32 s61, s49, 344512
  buffer_load_dwordx4 v2, s[8:11], s61 offen lds
  v_mfma_f32_16x16x32_bf16 v[220:223], v[172:175], v[100:103], v[220:223]
  s_add_u32 m0, s46, 73728
  s_add_u32 s61, s49, 344640
  buffer_load_dwordx4 v2, s[8:11], s61 offen lds
  v_mfma_f32_16x16x32_bf16 v[192:195], v[176:179], v[104:107], v[192:195]
  s_add_u32 m0, s46, 81920
  s_add_u32 s61, s49, 344768
  buffer_load_dwordx4 v2, s[8:11], s61 offen lds
  v_mfma_f32_16x16x32_bf16 v[208:211], v[176:179], v[108:111], v[208:211]
  s_add_u32 m0, s46, 90112
  s_add_u32 s61, s49, 344896
  s_mov_b64 exec, s[72:73]
  buffer_load_dwordx4 v2, s[8:11], s61 offen lds
  s_mov_b64 exec, -1
  v_mfma_f32_16x16x32_bf16 v[196:199], v[180:183], v[104:107], v[196:199]
  v_mfma_f32_16x16x32_bf16 v[212:215], v[180:183], v[108:111], v[212:215]
  v_mfma_f32_16x16x32_bf16 v[200:203], v[184:187], v[104:107], v[200:203]
  v_mfma_f32_16x16x32_bf16 v[216:219], v[184:187], v[108:111], v[216:219]
  v_mfma_f32_16x16x32_bf16 v[204:207], v[188:191], v[104:107], v[204:207]
  v_mfma_f32_16x16x32_bf16 v[220:223], v[188:191], v[108:111], v[220:223]
  s_waitcnt vmcnt(9) lgkmcnt(0)
  s_barrier
  v_mfma_f32_16x16x32_bf16 v[192:195], v[128:131], v[112:115], v[192:195]
  ds_read_b64_tr_b16 v[160:161], v1 offset:32768
  ds_read_b64_tr_b16 v[162:163], v1 offset:33792
  ds_read_b64_tr_b16 v[164:165], v3 offset:32768
  v_mfma_f32_16x16x32_bf16 v[208:211], v[128:131], v[116:119], v[208:211]
  ds_read_b64_tr_b16 v[166:167], v3 offset:33792
  ds_read_b64_tr_b16 v[168:169], v4 offset:32768
  ds_read_b64_tr_b16 v[170:171], v4 offset:33792
  v_mfma_f32_16x16x32_bf16 v[196:199], v[132:135], v[112:115], v[196:199]
  ds_read_b64_tr_b16 v[172:173], v12 offset:32768
  ds_read_b64_tr_b16 v[174:175], v12 offset:33792
  ds_read_b64_tr_b16 v[176:177], v1 offset:36864
  v_mfma_f32_16x16x32_bf16 v[212:215], v[132:135], v[116:119], v[212:215]
  ds_read_b64_tr_b16 v[178:179], v1 offset:37888
  ds_read_b64_tr_b16 v[180:181], v3 offset:36864
  ds_read_b64_tr_b16 v[182:183], v3 offset:37888
  v_mfma_f32_16x16x32_bf16 v[200:203], v[136:139], v[112:115], v[200:203]
  ds_read_b64_tr_b16 v[184:185], v4 offset:36864
  ds_read_b64_tr_b16 v[186:187], v4 offset:37888
  v_mfma_f32_16x16x32_bf16 v[216:219], v[136:139], v[116:119], v[216:219]
  ds_read_b64_tr_b16 v[188:189], v12 offset:36864
  ds_read_b64_tr_b16 v[190:191], v12 offset:37888
  v_mfma_f32_16x16x32_bf16 v[204:207], v[140:143], v[112:115], v[204:207]
  s_add_u32 m0, s46, 0
  s_add_u32 s61, s49, 516544
  buffer_load_dwordx4 v2, s[8:11], s61 offen lds
  v_mfma_f32_16x16x32_bf16 v[220:223], v[140:143], v[116:119], v[220:223]
  s_add_u32 m0, s46, 8192
  s_add_u32 s61, s49, 516672
  buffer_load_dwordx4 v2, s[8:11], s61 offen lds
  v_mfma_f32_16x16x32_bf16 v[192:195], v[144:147], v[120:123], v[192:195]
  s_add_u32 m0, s46, 16384
  s_add_u32 s61, s49, 516800
  buffer_load_dwordx4 v2, s[8:11], s61 offen lds
  v_mfma_f32_16x16x32_bf16 v[208:211], v[144:147], v[124:127], v[208:211]
  s_add_u32 m0, s46, 24576
  s_add_u32 s61, s49, 516928
  s_mov_b64 exec, s[72:73]
  buffer_load_dwordx4 v2, s[8:11], s61 offen lds
  s_mov_b64 exec, -1
  v_mfma_f32_16x16x32_bf16 v[196:199], v[148:151], v[120:123], v[196:199]
  v_mfma_f32_16x16x32_bf16 v[212:215], v[148:151], v[124:127], v[212:215]
  v_mfma_f32_16x16x32_bf16 v[200:203], v[152:155], v[120:123], v[200:203]
  v_mfma_f32_16x16x32_bf16 v[216:219], v[152:155], v[124:127], v[216:219]
  v_mfma_f32_16x16x32_bf16 v[204:207], v[156:159], v[120:123], v[204:207]
  v_mfma_f32_16x16x32_bf16 v[220:223], v[156:159], v[124:127], v[220:223]
  v_cvt_pk_bf16_f32 v224, v192, v193
  v_cvt_pk_bf16_f32 v225, v194, v195
  s_nop 0
  v_cvt_pk_bf16_f32 v226, v196, v197
  v_cvt_pk_bf16_f32 v227, v198, v199
  v_cvt_pk_bf16_f32 v232, v200, v201
  v_cvt_pk_bf16_f32 v233, v202, v203
  v_cvt_pk_bf16_f32 v234, v204, v205
  v_cvt_pk_bf16_f32 v235, v206, v207
  v_cvt_pk_bf16_f32 v228, v208, v209
  v_cvt_pk_bf16_f32 v229, v210, v211
  v_cvt_pk_bf16_f32 v230, v212, v213
  v_cvt_pk_bf16_f32 v231, v214, v215
  v_cvt_pk_bf16_f32 v236, v216, v217
  v_cvt_pk_bf16_f32 v237, v218, v219
  v_cvt_pk_bf16_f32 v238, v220, v221
  v_cvt_pk_bf16_f32 v239, v222, v223
  s_waitcnt vmcnt(9) lgkmcnt(0)
  s_barrier
  v_mfma_f32_16x16x32_bf16 v[192:195], v[160:163], v[16:19], 0
  ds_read_b64_tr_b16 v[128:129], v8 offset:32768
  ds_read_b64_tr_b16 v[130:131], v8 offset:33792
  ds_read_b64_tr_b16 v[132:133], v9 offset:32768
  v_mfma_f32_16x16x32_bf16 v[208:211], v[160:163], v[20:23], 0
  ds_read_b64_tr_b16 v[134:135], v9 offset:33792
  ds_read_b64_tr_b16 v[136:137], v10 offset:32768
  ds_read_b64_tr_b16 v[138:139], v10 offset:33792
  v_mfma_f32_16x16x32_bf16 v[196:199], v[164:167], v[16:19], 0
  ds_read_b64_tr_b16 v[140:141], v11 offset:32768
  ds_read_b64_tr_b16 v[142:143], v11 offset:33792
  ds_read_b64_tr_b16 v[144:145], v8 offset:36864
  v_mfma_f32_16x16x32_bf16 v[212:215], v[164:167], v[20:23], 0
  ds_read_b64_tr_b16 v[146:147], v8 offset:37888
  ds_read_b64_tr_b16 v[148:149], v9 offset:36864
  ds_read_b64_tr_b16 v[150:151], v9 offset:37888
  v_mfma_f32_16x16x32_bf16 v[200:203], v[168:171], v[16:19], 0
  ds_read_b64_tr_b16 v[152:153], v10 offset:36864
  ds_read_b64_tr_b16 v[154:155], v10 offset:37888
  v_mfma_f32_16x16x32_bf16 v[216:219], v[168:171], v[20:23], 0
  ds_read_b64_tr_b16 v[156:157], v11 offset:36864
  ds_read_b64_tr_b16 v[158:159], v11 offset:37888
  v_mfma_f32_16x16x32_bf16 v[204:207], v[172:175], v[16:19], 0
  s_add_u32 m0, s46, 98304
  s_add_u32 s61, s49, 688576
  buffer_load_dwordx4 v2, s[8:11], s61 offen lds
  v_mfma_f32_16x16x32_bf16 v[220:223], v[172:175], v[20:23], 0
  s_add_u32 m0, s46, 106496
  s_add_u32 s61, s49, 688704
  buffer_load_dwordx4 v2, s[8:11], s61 offen lds
  v_mfma_f32_16x16x32_bf16 v[192:195], v[176:179], v[24:27], v[192:195]
  s_add_u32 m0, s46, 114688
  s_add_u32 s61, s49, 688832
  buffer_load_dwordx4 v2, s[8:11], s61 offen lds
  v_mfma_f32_16x16x32_bf16 v[208:211], v[176:179], v[28:31], v[208:211]
  s_add_u32 m0, s46, 122880
  s_add_u32 s61, s49, 688960
  s_mov_b64 exec, s[72:73]
  buffer_load_dwordx4 v2, s[8:11], s61 offen lds
  s_mov_b64 exec, -1
  v_mfma_f32_16x16x32_bf16 v[196:199], v[180:183], v[24:27], v[196:199]
  v_mfma_f32_16x16x32_bf16 v[212:215], v[180:183], v[28:31], v[212:215]
  v_mfma_f32_16x16x32_bf16 v[200:203], v[184:187], v[24:27], v[200:203]
  v_mfma_f32_16x16x32_bf16 v[216:219], v[184:187], v[28:31], v[216:219]
  v_mfma_f32_16x16x32_bf16 v[204:207], v[188:191], v[24:27], v[204:207]
  v_mfma_f32_16x16x32_bf16 v[220:223], v[188:191], v[28:31], v[220:223]
  s_waitcnt vmcnt(8) lgkmcnt(0)
  s_barrier
  v_mfma_f32_16x16x32_bf16 v[192:195], v[128:131], v[32:35], v[192:195]
  ds_read_b64_tr_b16 v[160:161], v1 offset:0
  ds_read_b64_tr_b16 v[162:163], v1 offset:1024
  ds_read_b64_tr_b16 v[164:165], v3 offset:0
  v_mfma_f32_16x16x32_bf16 v[208:211], v[128:131], v[36:39], v[208:211]
  ds_read_b64_tr_b16 v[166:167], v3 offset:1024
  ds_read_b64_tr_b16 v[168:169], v4 offset:0
  ds_read_b64_tr_b16 v[170:171], v4 offset:1024
  v_mfma_f32_16x16x32_bf16 v[196:199], v[132:135], v[32:35], v[196:199]
  ds_read_b64_tr_b16 v[172:173], v12 offset:0
  ds_read_b64_tr_b16 v[174:175], v12 offset:1024
  ds_read_b64_tr_b16 v[176:177], v1 offset:4096
  v_mfma_f32_16x16x32_bf16 v[212:215], v[132:135], v[36:39], v[212:215]
  ds_read_b64_tr_b16 v[178:179], v1 offset:5120
  ds_read_b64_tr_b16 v[180:181], v3 offset:4096
  ds_read_b64_tr_b16 v[182:183], v3 offset:5120
  v_mfma_f32_16x16x32_bf16 v[200:203], v[136:139], v[32:35], v[200:203]
  ds_read_b64_tr_b16 v[184:185], v4 offset:4096
  ds_read_b64_tr_b16 v[186:187], v4 offset:5120
  v_mfma_f32_16x16x32_bf16 v[216:219], v[136:139], v[36:39], v[216:219]
  ds_read_b64_tr_b16 v[188:189], v12 offset:4096
  ds_read_b64_tr_b16 v[190:191], v12 offset:5120
  v_mfma_f32_16x16x32_bf16 v[204:207], v[140:143], v[32:35], v[204:207]
  s_add_u32 m0, s46, 32768
  s_add_u32 s61, s49, 860608
  buffer_load_dwordx4 v2, s[8:11], s61 offen lds
  s_add_u32 m0, s46, 40960
  s_add_u32 s61, s49, 860736
  buffer_load_dwordx4 v2, s[8:11], s61 offen lds
  v_mfma_f32_16x16x32_bf16 v[220:223], v[140:143], v[36:39], v[220:223]
  s_add_u32 m0, s46, 49152
  s_add_u32 s61, s49, 860864
  buffer_load_dwordx4 v2, s[8:11], s61 offen lds
  s_add_u32 m0, s46, 57344
  s_add_u32 s61, s49, 860992
  s_mov_b64 exec, s[72:73]
  buffer_load_dwordx4 v2, s[8:11], s61 offen lds
  s_mov_b64 exec, -1
  v_mfma_f32_16x16x32_bf16 v[192:195], v[144:147], v[40:43], v[192:195]
  s_mul_i32 s64, s50, 28
  v_and_b32 v242, 15, v0
  v_add_u32 v13, s64, v242
  v_lshrrev_b32 v243, 4, v0
  v_mfma_f32_16x16x32_bf16 v[208:211], v[144:147], v[44:47], v[208:211]
  v_and_b32 v14, 15, v13
  v_lshrrev_b32 v13, 4, v13
  v_mfma_f32_16x16x32_bf16 v[196:199], v[148:151], v[40:43], v[196:199]
  v_lshlrev_b32 v13, 16, v13
  v_lshl_add_u32 v13, v14, 4, v13
  v_mfma_f32_16x16x32_bf16 v[212:215], v[148:151], v[44:47], v[212:215]
  v_lshl_add_u32 v245, v243, 8, v13
  v_mfma_f32_16x16x32_bf16 v[200:203], v[152:155], v[40:43], v[200:203]
  v_add_u32 v246, 0x10000, v245
  v_mfma_f32_16x16x32_bf16 v[216:219], v[152:155], v[44:47], v[216:219]
  v_cmp_lt_u32 vcc, 11, v242
  v_mfma_f32_16x16x32_bf16 v[204:207], v[156:159], v[40:43], v[204:207]
  s_nop 0
  v_cndmask_b32 v246, v246, v245, vcc
  v_mfma_f32_16x16x32_bf16 v[220:223], v[156:159], v[44:47], v[220:223]
  s_cmp_eq_u32 s53, 1
  s_cselect_b64 vcc, -1, 0
  v_cndmask_b32 v244, v245, v246, vcc
  s_waitcnt vmcnt(8) lgkmcnt(0)
  s_barrier
  v_mfma_f32_16x16x32_bf16 v[192:195], v[160:163], v[48:51], v[192:195]
  ds_read_b64_tr_b16 v[128:129], v8 offset:0
  ds_read_b64_tr_b16 v[130:131], v8 offset:1024
  ds_read_b64_tr_b16 v[132:133], v9 offset:0
  v_mfma_f32_16x16x32_bf16 v[208:211], v[160:163], v[52:55], v[208:211]
  ds_read_b64_tr_b16 v[134:135], v9 offset:1024
  ds_read_b64_tr_b16 v[136:137], v10 offset:0
  ds_read_b64_tr_b16 v[138:139], v10 offset:1024
  v_mfma_f32_16x16x32_bf16 v[196:199], v[164:167], v[48:51], v[196:199]
  ds_read_b64_tr_b16 v[140:141], v11 offset:0
  ds_read_b64_tr_b16 v[142:143], v11 offset:1024
  ds_read_b64_tr_b16 v[144:145], v8 offset:4096
  v_mfma_f32_16x16x32_bf16 v[212:215], v[164:167], v[52:55], v[212:215]
  ds_read_b64_tr_b16 v[146:147], v8 offset:5120
  ds_read_b64_tr_b16 v[148:149], v9 offset:4096
  ds_read_b64_tr_b16 v[150:151], v9 offset:5120
  v_mfma_f32_16x16x32_bf16 v[200:203], v[168:171], v[48:51], v[200:203]
  ds_read_b64_tr_b16 v[152:153], v10 offset:4096
  ds_read_b64_tr_b16 v[154:155], v10 offset:5120
  v_mfma_f32_16x16x32_bf16 v[216:219], v[168:171], v[52:55], v[216:219]
  ds_read_b64_tr_b16 v[156:157], v11 offset:4096
  ds_read_b64_tr_b16 v[158:159], v11 offset:5120
  v_mfma_f32_16x16x32_bf16 v[204:207], v[172:175], v[48:51], v[204:207]
  s_add_u32 m0, s46, 65536
  s_add_u32 s61, s49, 1032640
  buffer_load_dwordx4 v2, s[8:11], s61 offen lds
  v_mfma_f32_16x16x32_bf16 v[220:223], v[172:175], v[52:55], v[220:223]
  s_add_u32 m0, s46, 73728
  s_add_u32 s61, s49, 1032768
  buffer_load_dwordx4 v2, s[8:11], s61 offen lds
  v_mfma_f32_16x16x32_bf16 v[192:195], v[176:179], v[56:59], v[192:195]
  s_add_u32 m0, s46, 81920
  s_add_u32 s61, s49, 1032896
  buffer_load_dwordx4 v2, s[8:11], s61 offen lds
  v_mfma_f32_16x16x32_bf16 v[208:211], v[176:179], v[60:63], v[208:211]
  s_add_u32 m0, s46, 90112
  s_add_u32 s61, s49, 1033024
  s_mov_b64 exec, s[72:73]
  buffer_load_dwordx4 v2, s[8:11], s61 offen lds
  s_mov_b64 exec, -1
  v_mfma_f32_16x16x32_bf16 v[196:199], v[180:183], v[56:59], v[196:199]
  s_lshl_b32 s54, s40, 13
  v_mfma_f32_16x16x32_bf16 v[212:215], v[180:183], v[60:63], v[212:215]
  s_add_u32 s54, s54, 4718592
  v_mfma_f32_16x16x32_bf16 v[200:203], v[184:187], v[56:59], v[200:203]
  v_mfma_f32_16x16x32_bf16 v[216:219], v[184:187], v[60:63], v[216:219]
  v_mfma_f32_16x16x32_bf16 v[204:207], v[188:191], v[56:59], v[204:207]
  v_mfma_f32_16x16x32_bf16 v[220:223], v[188:191], v[60:63], v[220:223]
  s_waitcnt vmcnt(8) lgkmcnt(0)
  s_barrier
  v_mfma_f32_16x16x32_bf16 v[192:195], v[128:131], v[64:67], v[192:195]
  ds_read_b64_tr_b16 v[160:161], v1 offset:32768
  ds_read_b64_tr_b16 v[162:163], v1 offset:33792
  ds_read_b64_tr_b16 v[164:165], v3 offset:32768
  v_mfma_f32_16x16x32_bf16 v[208:211], v[128:131], v[68:71], v[208:211]
  ds_read_b64_tr_b16 v[166:167], v3 offset:33792
  ds_read_b64_tr_b16 v[168:169], v4 offset:32768
  ds_read_b64_tr_b16 v[170:171], v4 offset:33792
  v_mfma_f32_16x16x32_bf16 v[196:199], v[132:135], v[64:67], v[196:199]
  ds_read_b64_tr_b16 v[172:173], v12 offset:32768
  ds_read_b64_tr_b16 v[174:175], v12 offset:33792
  ds_read_b64_tr_b16 v[176:177], v1 offset:36864
  v_mfma_f32_16x16x32_bf16 v[212:215], v[132:135], v[68:71], v[212:215]
  ds_read_b64_tr_b16 v[178:179], v1 offset:37888
  ds_read_b64_tr_b16 v[180:181], v3 offset:36864
  ds_read_b64_tr_b16 v[182:183], v3 offset:37888
  v_mfma_f32_16x16x32_bf16 v[200:203], v[136:139], v[64:67], v[200:203]
  ds_read_b64_tr_b16 v[184:185], v4 offset:36864
  ds_read_b64_tr_b16 v[186:187], v4 offset:37888
  v_mfma_f32_16x16x32_bf16 v[216:219], v[136:139], v[68:71], v[216:219]
  ds_read_b64_tr_b16 v[188:189], v12 offset:36864
  ds_read_b64_tr_b16 v[190:191], v12 offset:37888
  v_mfma_f32_16x16x32_bf16 v[204:207], v[140:143], v[64:67], v[204:207]
  buffer_store_dwordx4 v[248:251], v5, s[16:19], s56 offen offset:0 sc1
  v_mfma_f32_16x16x32_bf16 v[220:223], v[140:143], v[68:71], v[220:223]
  buffer_store_dwordx4 v[248:251], v5, s[16:19], s56 offen offset:1024 sc1
  v_mfma_f32_16x16x32_bf16 v[192:195], v[144:147], v[72:75], v[192:195]
  s_mul_i32 s64, s50, 28
  s_lshr_b32 s65, s64, 6
  s_add_u32 s64, s64, 27
  s_lshr_b32 s64, s64, 6
  s_sub_u32 s64, s64, s65
  v_bfe_u32 v13, v0, 2, 1
  v_mul_u32_u24 v13, s64, v13
  v_and_b32 v240, 3, v0
  v_lshl_add_u32 v240, v13, 5, v240
  s_lshl_b32 s64, s40, 2
  s_lshl_b32 s65, s65, 5
  s_add_u32 s64, s64, s65
  v_add_u32 v240, s64, v240
  v_mfma_f32_16x16x32_bf16 v[208:211], v[144:147], v[76:79], v[208:211]
  v_lshlrev_b32 v240, 7, v240
  v_mfma_f32_16x16x32_bf16 v[196:199], v[148:151], v[72:75], v[196:199]
  v_add_u32 v240, 32768, v240
  v_mfma_f32_16x16x32_bf16 v[212:215], v[148:151], v[76:79], v[212:215]
  v_lshlrev_b32 v13, 7, v0
  v_mfma_f32_16x16x32_bf16 v[200:203], v[152:155], v[72:75], v[200:203]
  v_add_u32 v13, 57344, v13
  v_mfma_f32_16x16x32_bf16 v[216:219], v[152:155], v[76:79], v[216:219]
  v_cmp_lt_u32 vcc, 31, v0
  v_mfma_f32_16x16x32_bf16 v[204:207], v[156:159], v[72:75], v[204:207]
  s_nop 0
  v_cndmask_b32 v240, v240, v13, vcc
  v_mfma_f32_16x16x32_bf16 v[220:223], v[156:159], v[76:79], v[220:223]
  s_mov_b32 s59, 0
  s_waitcnt vmcnt(6) lgkmcnt(0)
  s_barrier
  v_mfma_f32_16x16x32_bf16 v[192:195], v[160:163], v[80:83], v[192:195]
  ds_read_b64_tr_b16 v[128:129], v8 offset:32768
  ds_read_b64_tr_b16 v[130:131], v8 offset:33792
  ds_read_b64_tr_b16 v[132:133], v9 offset:32768
  v_mfma_f32_16x16x32_bf16 v[208:211], v[160:163], v[84:87], v[208:211]
  ds_read_b64_tr_b16 v[134:135], v9 offset:33792
  ds_read_b64_tr_b16 v[136:137], v10 offset:32768
  ds_read_b64_tr_b16 v[138:139], v10 offset:33792
  v_mfma_f32_16x16x32_bf16 v[196:199], v[164:167], v[80:83], v[196:199]
  ds_read_b64_tr_b16 v[140:141], v11 offset:32768
  ds_read_b64_tr_b16 v[142:143], v11 offset:33792
  ds_read_b64_tr_b16 v[144:145], v8 offset:36864
  v_mfma_f32_16x16x32_bf16 v[212:215], v[164:167], v[84:87], v[212:215]
  ds_read_b64_tr_b16 v[146:147], v8 offset:37888
  ds_read_b64_tr_b16 v[148:149], v9 offset:36864
  ds_read_b64_tr_b16 v[150:151], v9 offset:37888
  v_mfma_f32_16x16x32_bf16 v[200:203], v[168:171], v[80:83], v[200:203]
  ds_read_b64_tr_b16 v[152:153], v10 offset:36864
  ds_read_b64_tr_b16 v[154:155], v10 offset:37888
  v_mfma_f32_16x16x32_bf16 v[216:219], v[168:171], v[84:87], v[216:219]
  ds_read_b64_tr_b16 v[156:157], v11 offset:36864
  ds_read_b64_tr_b16 v[158:159], v11 offset:37888
  v_mfma_f32_16x16x32_bf16 v[204:207], v[172:175], v[80:83], v[204:207]
  buffer_store_dwordx4 v[248:251], v5, s[16:19], s56 offen offset:2048 sc1
  v_mfma_f32_16x16x32_bf16 v[220:223], v[172:175], v[84:87], v[220:223]
  buffer_store_dwordx4 v[248:251], v5, s[16:19], s56 offen offset:3072 sc1
  v_mfma_f32_16x16x32_bf16 v[192:195], v[176:179], v[88:91], v[192:195]
  v_mfma_f32_16x16x32_bf16 v[208:211], v[176:179], v[92:95], v[208:211]
  v_mfma_f32_16x16x32_bf16 v[196:199], v[180:183], v[88:91], v[196:199]
  v_mfma_f32_16x16x32_bf16 v[212:215], v[180:183], v[92:95], v[212:215]
  v_mfma_f32_16x16x32_bf16 v[200:203], v[184:187], v[88:91], v[200:203]
  v_mfma_f32_16x16x32_bf16 v[216:219], v[184:187], v[92:95], v[216:219]
  v_mfma_f32_16x16x32_bf16 v[204:207], v[188:191], v[88:91], v[204:207]
  v_mfma_f32_16x16x32_bf16 v[220:223], v[188:191], v[92:95], v[220:223]
  s_waitcnt vmcnt(4) lgkmcnt(0)
  s_barrier
  v_mfma_f32_16x16x32_bf16 v[192:195], v[128:131], v[96:99], v[192:195]
  ds_read_b64_tr_b16 v[160:161], v1 offset:0
  ds_read_b64_tr_b16 v[162:163], v1 offset:1024
  ds_read_b64_tr_b16 v[164:165], v3 offset:0
  v_mfma_f32_16x16x32_bf16 v[208:211], v[128:131], v[100:103], v[208:211]
  ds_read_b64_tr_b16 v[166:167], v3 offset:1024
  ds_read_b64_tr_b16 v[168:169], v4 offset:0
  ds_read_b64_tr_b16 v[170:171], v4 offset:1024
  v_mfma_f32_16x16x32_bf16 v[196:199], v[132:135], v[96:99], v[196:199]
  ds_read_b64_tr_b16 v[172:173], v12 offset:0
  ds_read_b64_tr_b16 v[174:175], v12 offset:1024
  ds_read_b64_tr_b16 v[176:177], v1 offset:4096
  v_mfma_f32_16x16x32_bf16 v[212:215], v[132:135], v[100:103], v[212:215]
  ds_read_b64_tr_b16 v[178:179], v1 offset:5120
  ds_read_b64_tr_b16 v[180:181], v3 offset:4096
  ds_read_b64_tr_b16 v[182:183], v3 offset:5120
  v_mfma_f32_16x16x32_bf16 v[200:203], v[136:139], v[96:99], v[200:203]
  ds_read_b64_tr_b16 v[184:185], v4 offset:4096
  ds_read_b64_tr_b16 v[186:187], v4 offset:5120
  v_mfma_f32_16x16x32_bf16 v[216:219], v[136:139], v[100:103], v[216:219]
  ds_read_b64_tr_b16 v[188:189], v12 offset:4096
  ds_read_b64_tr_b16 v[190:191], v12 offset:5120
  v_mfma_f32_16x16x32_bf16 v[204:207], v[140:143], v[96:99], v[204:207]
  s_add_u32 s68, s56, 4096
  buffer_store_dwordx4 v[248:251], v5, s[16:19], s68 offen offset:0 sc1
  v_mfma_f32_16x16x32_bf16 v[220:223], v[140:143], v[100:103], v[220:223]
  s_add_u32 s68, s56, 4096
  buffer_store_dwordx4 v[248:251], v5, s[16:19], s68 offen offset:1024 sc1
  v_mfma_f32_16x16x32_bf16 v[192:195], v[144:147], v[104:107], v[192:195]
  v_mfma_f32_16x16x32_bf16 v[208:211], v[144:147], v[108:111], v[208:211]
  v_mfma_f32_16x16x32_bf16 v[196:199], v[148:151], v[104:107], v[196:199]
  v_mfma_f32_16x16x32_bf16 v[212:215], v[148:151], v[108:111], v[212:215]
  v_mfma_f32_16x16x32_bf16 v[200:203], v[152:155], v[104:107], v[200:203]
  v_mfma_f32_16x16x32_bf16 v[216:219], v[152:155], v[108:111], v[216:219]
  v_mfma_f32_16x16x32_bf16 v[204:207], v[156:159], v[104:107], v[204:207]
  v_mfma_f32_16x16x32_bf16 v[220:223], v[156:159], v[108:111], v[220:223]
  s_waitcnt lgkmcnt(0)
  s_barrier
  v_mfma_f32_16x16x32_bf16 v[192:195], v[160:163], v[112:115], v[192:195]
  v_mfma_f32_16x16x32_bf16 v[208:211], v[160:163], v[116:119], v[208:211]
  v_mfma_f32_16x16x32_bf16 v[196:199], v[164:167], v[112:115], v[196:199]
  v_mfma_f32_16x16x32_bf16 v[212:215], v[164:167], v[116:119], v[212:215]
  v_mfma_f32_16x16x32_bf16 v[200:203], v[168:171], v[112:115], v[200:203]
  v_mfma_f32_16x16x32_bf16 v[216:219], v[168:171], v[116:119], v[216:219]
  v_mfma_f32_16x16x32_bf16 v[204:207], v[172:175], v[112:115], v[204:207]
  s_add_u32 s68, s56, 4096
  buffer_store_dwordx4 v[248:251], v5, s[16:19], s68 offen offset:2048 sc1
  v_mfma_f32_16x16x32_bf16 v[220:223], v[172:175], v[116:119], v[220:223]
  v_mfma_f32_16x16x32_bf16 v[192:195], v[176:179], v[120:123], v[192:195]
  v_mfma_f32_16x16x32_bf16 v[208:211], v[176:179], v[124:127], v[208:211]
  v_mfma_f32_16x16x32_bf16 v[196:199], v[180:183], v[120:123], v[196:199]
  v_mfma_f32_16x16x32_bf16 v[212:215], v[180:183], v[124:127], v[212:215]
  v_mfma_f32_16x16x32_bf16 v[200:203], v[184:187], v[120:123], v[200:203]
  v_mfma_f32_16x16x32_bf16 v[216:219], v[184:187], v[124:127], v[216:219]
  v_mfma_f32_16x16x32_bf16 v[204:207], v[188:191], v[120:123], v[204:207]
  v_mfma_f32_16x16x32_bf16 v[220:223], v[188:191], v[124:127], v[220:223]
  s_nop 0
  v_mul_f32 v128, 0x3fb8aa3b, v192
  v_mul_f32 v129, 0x3fb8aa3b, v193
  v_mul_f32 v130, 0x3fb8aa3b, v194
  v_mul_f32 v131, 0x3fb8aa3b, v195
  v_mul_f32 v132, 0x3fb8aa3b, v196
  v_mul_f32 v133, 0x3fb8aa3b, v197
  v_mul_f32 v134, 0x3fb8aa3b, v198
  v_mul_f32 v135, 0x3fb8aa3b, v199
  v_mul_f32 v136, 0x3fb8aa3b, v200
  v_mul_f32 v137, 0x3fb8aa3b, v201
  v_mul_f32 v138, 0x3fb8aa3b, v202
  v_mul_f32 v139, 0x3fb8aa3b, v203
  v_mul_f32 v140, 0x3fb8aa3b, v204
  v_mul_f32 v141, 0x3fb8aa3b, v205
  v_mul_f32 v142, 0x3fb8aa3b, v206
  v_mul_f32 v143, 0x3fb8aa3b, v207
  v_exp_f32_e64 v128, v128 clamp
  v_exp_f32_e64 v129, v129 clamp
  v_exp_f32_e64 v130, v130 clamp
  v_exp_f32_e64 v131, v131 clamp
  v_exp_f32_e64 v132, v132 clamp
  v_exp_f32_e64 v133, v133 clamp
  v_exp_f32_e64 v134, v134 clamp
  v_exp_f32_e64 v135, v135 clamp
  v_exp_f32_e64 v136, v136 clamp
  v_exp_f32_e64 v137, v137 clamp
  v_exp_f32_e64 v138, v138 clamp
  v_exp_f32_e64 v139, v139 clamp
  v_exp_f32_e64 v140, v140 clamp
  v_exp_f32_e64 v141, v141 clamp
  v_exp_f32_e64 v142, v142 clamp
  v_exp_f32_e64 v143, v143 clamp
  v_max_f32 v192, 0, v192
  v_max_f32 v193, 0, v193
  v_max_f32 v194, 0, v194
  v_max_f32 v195, 0, v195
  v_max_f32 v196, 0, v196
  v_max_f32 v197, 0, v197
  v_max_f32 v198, 0, v198
  v_max_f32 v199, 0, v199
  v_max_f32 v200, 0, v200
  v_max_f32 v201, 0, v201
  v_max_f32 v202, 0, v202
  v_max_f32 v203, 0, v203
  v_max_f32 v204, 0, v204
  v_max_f32 v205, 0, v205
  v_max_f32 v206, 0, v206
  v_max_f32 v207, 0, v207
  v_add_f32 v192, v192, v128
  v_add_f32 v193, v193, v129
  v_add_f32 v194, v194, v130
  v_add_f32 v195, v195, v131
  v_add_f32 v196, v196, v132
  v_add_f32 v197, v197, v133
  v_add_f32 v198, v198, v134
  v_add_f32 v199, v199, v135
  v_add_f32 v200, v200, v136
  v_add_f32 v201, v201, v137
  v_add_f32 v202, v202, v138
  v_add_f32 v203, v203, v139
  v_add_f32 v204, v204, v140
  v_add_f32 v205, v205, v141
  v_add_f32 v206, v206, v142
  v_add_f32 v207, v207, v143
  v_add_f32 v192, 0x358637bd, v192
  v_add_f32 v193, 0x358637bd, v193
  v_add_f32 v194, 0x358637bd, v194
  v_add_f32 v195, 0x358637bd, v195
  v_add_f32 v196, 0x358637bd, v196
  v_add_f32 v197, 0x358637bd, v197
  v_add_f32 v198, 0x358637bd, v198
  v_add_f32 v199, 0x358637bd, v199
  v_add_f32 v200, 0x358637bd, v200
  v_add_f32 v201, 0x358637bd, v201
  v_add_f32 v202, 0x358637bd, v202
  v_add_f32 v203, 0x358637bd, v203
  buffer_load_dword v241, v240, s[16:19], s59 offen sc1
  v_add_f32 v204, 0x358637bd, v204
  v_add_f32 v205, 0x358637bd, v205
  v_add_f32 v206, 0x358637bd, v206
  v_add_f32 v207, 0x358637bd, v207
  v_mul_f32 v128, 0x3fb8aa3b, v208
  v_mul_f32 v129, 0x3fb8aa3b, v209
  v_mul_f32 v130, 0x3fb8aa3b, v210
  v_mul_f32 v131, 0x3fb8aa3b, v211
  v_mul_f32 v132, 0x3fb8aa3b, v212
  v_mul_f32 v133, 0x3fb8aa3b, v213
  v_mul_f32 v134, 0x3fb8aa3b, v214
  v_mul_f32 v135, 0x3fb8aa3b, v215
  v_mul_f32 v136, 0x3fb8aa3b, v216
  v_mul_f32 v137, 0x3fb8aa3b, v217
  v_mul_f32 v138, 0x3fb8aa3b, v218
  v_mul_f32 v139, 0x3fb8aa3b, v219
  v_mul_f32 v140, 0x3fb8aa3b, v220
  v_mul_f32 v141, 0x3fb8aa3b, v221
  v_mul_f32 v142, 0x3fb8aa3b, v222
  v_mul_f32 v143, 0x3fb8aa3b, v223
  v_exp_f32_e64 v128, v128 clamp
  v_exp_f32_e64 v129, v129 clamp
  v_exp_f32_e64 v130, v130 clamp
  v_exp_f32_e64 v131, v131 clamp
  v_exp_f32_e64 v132, v132 clamp
  v_exp_f32_e64 v133, v133 clamp
  v_exp_f32_e64 v134, v134 clamp
  v_exp_f32_e64 v135, v135 clamp
  v_exp_f32_e64 v136, v136 clamp
  v_exp_f32_e64 v137, v137 clamp
  v_exp_f32_e64 v138, v138 clamp
  v_exp_f32_e64 v139, v139 clamp
  v_exp_f32_e64 v140, v140 clamp
  v_exp_f32_e64 v141, v141 clamp
  v_exp_f32_e64 v142, v142 clamp
  v_exp_f32_e64 v143, v143 clamp
  v_max_f32 v208, 0, v208
  v_max_f32 v209, 0, v209
  v_max_f32 v210, 0, v210
  v_max_f32 v211, 0, v211
  v_max_f32 v212, 0, v212
  v_max_f32 v213, 0, v213
  v_max_f32 v214, 0, v214
  v_max_f32 v215, 0, v215
  v_max_f32 v216, 0, v216
  v_max_f32 v217, 0, v217
  v_max_f32 v218, 0, v218
  v_max_f32 v219, 0, v219
  v_max_f32 v220, 0, v220
  v_max_f32 v221, 0, v221
  v_max_f32 v222, 0, v222
  v_max_f32 v223, 0, v223
  v_add_f32 v208, v208, v128
  v_add_f32 v209, v209, v129
  v_add_f32 v210, v210, v130
  v_add_f32 v211, v211, v131
  v_add_f32 v212, v212, v132
  v_add_f32 v213, v213, v133
  v_add_f32 v214, v214, v134
  v_add_f32 v215, v215, v135
  v_add_f32 v216, v216, v136
  v_add_f32 v217, v217, v137
  v_add_f32 v218, v218, v138
  v_add_f32 v219, v219, v139
  v_add_f32 v220, v220, v140
  v_add_f32 v221, v221, v141
  v_add_f32 v222, v222, v142
  v_add_f32 v223, v223, v143
  v_add_f32 v208, 0x358637bd, v208
  v_add_f32 v209, 0x358637bd, v209
  v_add_f32 v210, 0x358637bd, v210
  v_add_f32 v211, 0x358637bd, v211
  v_add_f32 v212, 0x358637bd, v212
  v_add_f32 v213, 0x358637bd, v213
  v_add_f32 v214, 0x358637bd, v214
  v_add_f32 v215, 0x358637bd, v215
  v_add_f32 v216, 0x358637bd, v216
  v_add_f32 v217, 0x358637bd, v217
  v_add_f32 v218, 0x358637bd, v218
  v_add_f32 v219, 0x358637bd, v219
  v_add_f32 v220, 0x358637bd, v220
  v_add_f32 v221, 0x358637bd, v221
  v_add_f32 v222, 0x358637bd, v222
  v_add_f32 v223, 0x358637bd, v223
  v_cvt_pk_bf16_f32 v176, v192, v193
  v_cvt_pk_bf16_f32 v177, v194, v195
  v_cvt_pk_bf16_f32 v178, v196, v197
  v_cvt_pk_bf16_f32 v179, v198, v199
  v_cvt_pk_bf16_f32 v184, v200, v201
  v_cvt_pk_bf16_f32 v185, v202, v203
  v_cvt_pk_bf16_f32 v186, v204, v205
  v_cvt_pk_bf16_f32 v187, v206, v207
  v_cvt_pk_bf16_f32 v180, v208, v209
  v_cvt_pk_bf16_f32 v181, v210, v211
  v_cvt_pk_bf16_f32 v182, v212, v213
  v_cvt_pk_bf16_f32 v183, v214, v215
  v_cvt_pk_bf16_f32 v188, v216, v217
  v_cvt_pk_bf16_f32 v189, v218, v219
  v_cvt_pk_bf16_f32 v190, v220, v221
  v_cvt_pk_bf16_f32 v191, v222, v223
  v_lshlrev_b32 v192, 16, v224
  v_and_b32 v193, 0xffff0000, v224
  v_lshlrev_b32 v194, 16, v225
  v_and_b32 v195, 0xffff0000, v225
  v_lshlrev_b32 v196, 16, v226
  v_and_b32 v197, 0xffff0000, v226
  v_lshlrev_b32 v198, 16, v227
  v_and_b32 v199, 0xffff0000, v227
  v_lshlrev_b32 v200, 16, v232
  v_and_b32 v201, 0xffff0000, v232
  v_lshlrev_b32 v202, 16, v233
  v_and_b32 v203, 0xffff0000, v233
  v_lshlrev_b32 v204, 16, v234
  v_and_b32 v205, 0xffff0000, v234
  v_lshlrev_b32 v206, 16, v235
  v_and_b32 v207, 0xffff0000, v235
  s_waitcnt vmcnt(0)
  s_movk_i32 s62, 0x1000
  s_branch PC_23
PL_21:
  buffer_load_dword v241, v240, s[16:19], s59 offen sc1
  s_waitcnt vmcnt(0)
PC_23:
  v_cmp_ne_u32 vcc, s43, v241
  s_nop 1
  s_cbranch_vccz PD_22
  s_sleep 2
  s_sub_u32 s62, s62, 1
  s_cbranch_scc0 PL_21
PD_22:
  s_nop 1
  s_add_u32 s57, s54, 1835008
  s_add_u32 s55, s54, 4096
  s_add_u32 s63, s57, 4096
  buffer_load_dwordx4 v[48:51], v245, s[16:19], s57 offen offset:0 sc1
  v_lshlrev_b32 v208, 16, v228
  v_and_b32 v209, 0xffff0000, v228
  v_lshlrev_b32 v210, 16, v229
  v_and_b32 v211, 0xffff0000, v229
  v_lshlrev_b32 v212, 16, v230
  v_and_b32 v213, 0xffff0000, v230
  v_lshlrev_b32 v214, 16, v231
  v_and_b32 v215, 0xffff0000, v231
  buffer_load_dwordx4 v[52:55], v246, s[16:19], s57 offen offset:0 sc1
  v_lshlrev_b32 v216, 16, v236
  v_and_b32 v217, 0xffff0000, v236
  v_lshlrev_b32 v218, 16, v237
  v_and_b32 v219, 0xffff0000, v237
  v_lshlrev_b32 v220, 16, v238
  v_and_b32 v221, 0xffff0000, v238
  v_lshlrev_b32 v222, 16, v239
  v_and_b32 v223, 0xffff0000, v239
  buffer_load_dwordx4 v[16:19], v244, s[16:19], s54 offen offset:0 sc1
  v_mul_f32 v128, 0x3fb8aa3b, v192
  v_mul_f32 v129, 0x3fb8aa3b, v193
  v_mul_f32 v130, 0x3fb8aa3b, v194
  v_mul_f32 v131, 0x3fb8aa3b, v195
  v_mul_f32 v132, 0x3fb8aa3b, v196
  v_mul_f32 v133, 0x3fb8aa3b, v197
  v_mul_f32 v134, 0x3fb8aa3b, v198
  v_mul_f32 v135, 0x3fb8aa3b, v199
  buffer_load_dwordx4 v[56:59], v245, s[16:19], s57 offen offset:1024 sc1
  v_mul_f32 v136, 0x3fb8aa3b, v200
  v_mul_f32 v137, 0x3fb8aa3b, v201
  v_mul_f32 v138, 0x3fb8aa3b, v202
  v_mul_f32 v139, 0x3fb8aa3b, v203
  v_mul_f32 v140, 0x3fb8aa3b, v204
  v_mul_f32 v141, 0x3fb8aa3b, v205
  v_mul_f32 v142, 0x3fb8aa3b, v206
  v_mul_f32 v143, 0x3fb8aa3b, v207
  buffer_load_dwordx4 v[60:63], v246, s[16:19], s57 offen offset:1024 sc1
  v_exp_f32_e64 v128, v128 clamp
  v_exp_f32_e64 v129, v129 clamp
  v_exp_f32_e64 v130, v130 clamp
  v_exp_f32_e64 v131, v131 clamp
  v_exp_f32_e64 v132, v132 clamp
  v_exp_f32_e64 v133, v133 clamp
  v_exp_f32_e64 v134, v134 clamp
  v_exp_f32_e64 v135, v135 clamp
  buffer_load_dwordx4 v[20:23], v244, s[16:19], s54 offen offset:1024 sc1
  v_exp_f32_e64 v136, v136 clamp
  v_exp_f32_e64 v137, v137 clamp
  v_exp_f32_e64 v138, v138 clamp
  v_exp_f32_e64 v139, v139 clamp
  v_exp_f32_e64 v140, v140 clamp
  v_exp_f32_e64 v141, v141 clamp
  v_exp_f32_e64 v142, v142 clamp
  v_exp_f32_e64 v143, v143 clamp
  buffer_load_dwordx4 v[64:67], v245, s[16:19], s57 offen offset:2048 sc1
  v_max_f32 v192, 0, v192
  v_max_f32 v193, 0, v193
  v_max_f32 v194, 0, v194
  v_max_f32 v195, 0, v195
  v_max_f32 v196, 0, v196
  v_max_f32 v197, 0, v197
  v_max_f32 v198, 0, v198
  v_max_f32 v199, 0, v199
  buffer_load_dwordx4 v[68:71], v246, s[16:19], s57 offen offset:2048 sc1
  v_max_f32 v200, 0, v200
  v_max_f32 v201, 0, v201
  v_max_f32 v202, 0, v202
  v_max_f32 v203, 0, v203
  v_max_f32 v204, 0, v204
  v_max_f32 v205, 0, v205
  v_max_f32 v206, 0, v206
  v_max_f32 v207, 0, v207
  buffer_load_dwordx4 v[24:27], v244, s[16:19], s54 offen offset:2048 sc1
  v_add_f32 v192, v192, v128
  v_add_f32 v193, v193, v129
  v_add_f32 v194, v194, v130
  v_add_f32 v195, v195, v131
  v_add_f32 v196, v196, v132
  v_add_f32 v197, v197, v133
  v_add_f32 v198, v198, v134
  v_add_f32 v199, v199, v135
  buffer_load_dwordx4 v[72:75], v245, s[16:19], s57 offen offset:3072 sc1
  v_add_f32 v200, v200, v136
  v_add_f32 v201, v201, v137
  v_add_f32 v202, v202, v138
  v_add_f32 v203, v203, v139
  v_add_f32 v204, v204, v140
  v_add_f32 v205, v205, v141
  v_add_f32 v206, v206, v142
  v_add_f32 v207, v207, v143
  buffer_load_dwordx4 v[76:79], v246, s[16:19], s57 offen offset:3072 sc1
  v_add_f32 v192, 0x358637bd, v192
  v_add_f32 v193, 0x358637bd, v193
  v_add_f32 v194, 0x358637bd, v194
  v_add_f32 v195, 0x358637bd, v195
  v_add_f32 v196, 0x358637bd, v196
  v_add_f32 v197, 0x358637bd, v197
  v_add_f32 v198, 0x358637bd, v198
  v_add_f32 v199, 0x358637bd, v199
  buffer_load_dwordx4 v[28:31], v244, s[16:19], s54 offen offset:3072 sc1
  v_add_f32 v200, 0x358637bd, v200
  v_add_f32 v201, 0x358637bd, v201
  v_add_f32 v202, 0x358637bd, v202
  v_add_f32 v203, 0x358637bd, v203
  v_add_f32 v204, 0x358637bd, v204
  v_add_f32 v205, 0x358637bd, v205
  v_add_f32 v206, 0x358637bd, v206
  v_add_f32 v207, 0x358637bd, v207
  buffer_load_dwordx4 v[80:83], v245, s[16:19], s63 offen offset:0 sc1
  v_mul_f32 v128, 0x3fb8aa3b, v208
  v_mul_f32 v129, 0x3fb8aa3b, v209
  v_mul_f32 v130, 0x3fb8aa3b, v210
  v_mul_f32 v131, 0x3fb8aa3b, v211
  v_mul_f32 v132, 0x3fb8aa3b, v212
  v_mul_f32 v133, 0x3fb8aa3b, v213
  v_mul_f32 v134, 0x3fb8aa3b, v214
  v_mul_f32 v135, 0x3fb8aa3b, v215
  buffer_load_dwordx4 v[84:87], v246, s[16:19], s63 offen offset:0 sc1
  v_mul_f32 v136, 0x3fb8aa3b, v216
  v_mul_f32 v137, 0x3fb8aa3b, v217
  v_mul_f32 v138, 0x3fb8aa3b, v218
  v_mul_f32 v139, 0x3fb8aa3b, v219
  v_mul_f32 v140, 0x3fb8aa3b, v220
  v_mul_f32 v141, 0x3fb8aa3b, v221
  v_mul_f32 v142, 0x3fb8aa3b, v222
  v_mul_f32 v143, 0x3fb8aa3b, v223
  buffer_load_dwordx4 v[32:35], v244, s[16:19], s55 offen offset:0 sc1
  v_exp_f32_e64 v128, v128 clamp
  v_exp_f32_e64 v129, v129 clamp
  v_exp_f32_e64 v130, v130 clamp
  v_exp_f32_e64 v131, v131 clamp
  v_exp_f32_e64 v132, v132 clamp
  v_exp_f32_e64 v133, v133 clamp
  v_exp_f32_e64 v134, v134 clamp
  v_exp_f32_e64 v135, v135 clamp
  buffer_load_dwordx4 v[88:91], v245, s[16:19], s63 offen offset:1024 sc1
  v_exp_f32_e64 v136, v136 clamp
  v_exp_f32_e64 v137, v137 clamp
  v_exp_f32_e64 v138, v138 clamp
  v_exp_f32_e64 v139, v139 clamp
  v_exp_f32_e64 v140, v140 clamp
  v_exp_f32_e64 v141, v141 clamp
  v_exp_f32_e64 v142, v142 clamp
  v_exp_f32_e64 v143, v143 clamp
  buffer_load_dwordx4 v[92:95], v246, s[16:19], s63 offen offset:1024 sc1
  v_max_f32 v208, 0, v208
  v_max_f32 v209, 0, v209
  v_max_f32 v210, 0, v210
  v_max_f32 v211, 0, v211
  v_max_f32 v212, 0, v212
  v_max_f32 v213, 0, v213
  v_max_f32 v214, 0, v214
  v_max_f32 v215, 0, v215
  buffer_load_dwordx4 v[36:39], v244, s[16:19], s55 offen offset:1024 sc1
  v_max_f32 v216, 0, v216
  v_max_f32 v217, 0, v217
  v_max_f32 v218, 0, v218
  v_max_f32 v219, 0, v219
  v_max_f32 v220, 0, v220
  v_max_f32 v221, 0, v221
  v_max_f32 v222, 0, v222
  v_max_f32 v223, 0, v223
  buffer_load_dwordx4 v[96:99], v245, s[16:19], s63 offen offset:2048 sc1
  v_add_f32 v208, v208, v128
  v_add_f32 v209, v209, v129
  v_add_f32 v210, v210, v130
  v_add_f32 v211, v211, v131
  v_add_f32 v212, v212, v132
  v_add_f32 v213, v213, v133
  v_add_f32 v214, v214, v134
  v_add_f32 v215, v215, v135
  buffer_load_dwordx4 v[100:103], v246, s[16:19], s63 offen offset:2048 sc1
  v_add_f32 v216, v216, v136
  v_add_f32 v217, v217, v137
  v_add_f32 v218, v218, v138
  v_add_f32 v219, v219, v139
  v_add_f32 v220, v220, v140
  v_add_f32 v221, v221, v141
  v_add_f32 v222, v222, v142
  v_add_f32 v223, v223, v143
  buffer_load_dwordx4 v[40:43], v244, s[16:19], s55 offen offset:2048 sc1
  v_add_f32 v208, 0x358637bd, v208
  v_add_f32 v209, 0x358637bd, v209
  v_add_f32 v210, 0x358637bd, v210
  v_add_f32 v211, 0x358637bd, v211
  v_add_f32 v212, 0x358637bd, v212
  v_add_f32 v213, 0x358637bd, v213
  v_add_f32 v214, 0x358637bd, v214
  v_add_f32 v215, 0x358637bd, v215
  buffer_load_dwordx4 v[104:107], v245, s[16:19], s63 offen offset:3072 sc1
  v_add_f32 v216, 0x358637bd, v216
  v_add_f32 v217, 0x358637bd, v217
  v_add_f32 v218, 0x358637bd, v218
  v_add_f32 v219, 0x358637bd, v219
  v_add_f32 v220, 0x358637bd, v220
  v_add_f32 v221, 0x358637bd, v221
  v_add_f32 v222, 0x358637bd, v222
  v_add_f32 v223, 0x358637bd, v223
  buffer_load_dwordx4 v[108:111], v246, s[16:19], s63 offen offset:3072 sc1
  v_cvt_pk_bf16_f32 v224, v192, v193
  v_cvt_pk_bf16_f32 v225, v194, v195
  v_cvt_pk_bf16_f32 v226, v196, v197
  v_cvt_pk_bf16_f32 v227, v198, v199
  v_cvt_pk_bf16_f32 v232, v200, v201
  v_cvt_pk_bf16_f32 v233, v202, v203
  v_cvt_pk_bf16_f32 v234, v204, v205
  v_cvt_pk_bf16_f32 v235, v206, v207
  buffer_load_dwordx4 v[44:47], v244, s[16:19], s55 offen offset:3072 sc1
  v_cvt_pk_bf16_f32 v228, v208, v209
  v_cvt_pk_bf16_f32 v229, v210, v211
  v_cvt_pk_bf16_f32 v230, v212, v213
  v_cvt_pk_bf16_f32 v231, v214, v215
  v_cvt_pk_bf16_f32 v236, v216, v217
  v_cvt_pk_bf16_f32 v237, v218, v219
  v_cvt_pk_bf16_f32 v238, v220, v221
  v_cvt_pk_bf16_f32 v239, v222, v223
  v_mov_b32 v124, 0x3f803f80
  v_mov_b32 v125, 0x3f803f80
  v_mov_b32 v126, 0x3f803f80
  v_mov_b32 v127, 0x3f803f80
  s_mul_i32 s64, s40, 3072
  v_add_u32 v2, s64, v5
  v_add_u32 v3, s46, v5
  s_waitcnt vmcnt(21)
  v_mfma_f32_16x16x32_bf16 v[112:115], v[16:19], v[48:51], 0
  v_mfma_f32_16x16x32_bf16 v[116:119], v[16:19], v[52:55], 0
  v_mfma_f32_16x16x32_bf16 v[120:123], v[16:19], v[124:127], 0
  s_waitcnt vmcnt(18)
  v_mfma_f32_16x16x32_bf16 v[112:115], v[20:23], v[56:59], v[112:115]
  v_mfma_f32_16x16x32_bf16 v[116:119], v[20:23], v[60:63], v[116:119]
  v_mfma_f32_16x16x32_bf16 v[120:123], v[20:23], v[124:127], v[120:123]
  s_waitcnt vmcnt(15)
  v_mfma_f32_16x16x32_bf16 v[112:115], v[24:27], v[64:67], v[112:115]
  v_mfma_f32_16x16x32_bf16 v[116:119], v[24:27], v[68:71], v[116:119]
  v_mfma_f32_16x16x32_bf16 v[120:123], v[24:27], v[124:127], v[120:123]
  s_waitcnt vmcnt(12)
  v_mfma_f32_16x16x32_bf16 v[112:115], v[28:31], v[72:75], v[112:115]
  v_mfma_f32_16x16x32_bf16 v[116:119], v[28:31], v[76:79], v[116:119]
  v_mfma_f32_16x16x32_bf16 v[120:123], v[28:31], v[124:127], v[120:123]
  s_waitcnt vmcnt(9)
  v_mfma_f32_16x16x32_bf16 v[112:115], v[32:35], v[80:83], v[112:115]
  v_mfma_f32_16x16x32_bf16 v[116:119], v[32:35], v[84:87], v[116:119]
  v_mfma_f32_16x16x32_bf16 v[120:123], v[32:35], v[124:127], v[120:123]
  s_waitcnt vmcnt(6)
  v_mfma_f32_16x16x32_bf16 v[112:115], v[36:39], v[88:91], v[112:115]
  v_mfma_f32_16x16x32_bf16 v[116:119], v[36:39], v[92:95], v[116:119]
  v_mfma_f32_16x16x32_bf16 v[120:123], v[36:39], v[124:127], v[120:123]
  s_waitcnt vmcnt(3)
  v_mfma_f32_16x16x32_bf16 v[112:115], v[40:43], v[96:99], v[112:115]
  v_mfma_f32_16x16x32_bf16 v[116:119], v[40:43], v[100:103], v[116:119]
  v_mfma_f32_16x16x32_bf16 v[120:123], v[40:43], v[124:127], v[120:123]
  s_waitcnt vmcnt(0)
  v_mfma_f32_16x16x32_bf16 v[112:115], v[44:47], v[104:107], v[112:115]
  v_mfma_f32_16x16x32_bf16 v[116:119], v[44:47], v[108:111], v[116:119]
  v_mfma_f32_16x16x32_bf16 v[120:123], v[44:47], v[124:127], v[120:123]
  s_nop 5
  ds_write_b128 v2, v[112:115] offset:0
  ds_write_b128 v2, v[116:119] offset:1024
  ds_write_b128 v2, v[120:123] offset:2048
  s_waitcnt vmcnt(0) lgkmcnt(0)
  s_barrier
  s_cmp_lg_u32 s40, 3
  s_cbranch_scc1 OW_24
  s_lshl_b32 s64, s41, 2
  s_add_u32 s64, s64, 98304
  s_mov_b64 exec, 1
  v_mov_b32 v14, s43
  buffer_store_dword v14, off, s[16:19], s64 sc1
  s_mov_b64 exec, -1
  s_nop 4
OW_24:
  s_mul_i32 s55, s44, 6144
  s_add_u32 s55, s55, 294912
  s_movk_i32 s62, 0x1000
  s_cmp_gt_u32 s40, 2
  s_cbranch_scc1 L_AH
  ds_read_b128 v[16:19], v3 offset:0
  ds_read_b128 v[20:23], v3 offset:3072
  ds_read_b128 v[24:27], v3 offset:6144
  ds_read_b128 v[28:31], v3 offset:9216
  ds_read_b128 v[32:35], v3 offset:12288
  ds_read_b128 v[36:39], v3 offset:15360
  ds_read_b128 v[40:43], v3 offset:18432
  ds_read_b128 v[44:47], v3 offset:21504
  s_cmp_eq_u32 s53, 1
  s_cselect_b32 vcc_hi, 0xffff0000, 0
  s_mov_b32 vcc_lo, 0
  s_waitcnt lgkmcnt(3)
  v_pk_add_f32 v[16:17], v[16:17], v[32:33]
  v_pk_add_f32 v[18:19], v[18:19], v[34:35]
  s_waitcnt lgkmcnt(2)
  v_pk_add_f32 v[20:21], v[20:21], v[36:37]
  v_pk_add_f32 v[22:23], v[22:23], v[38:39]
  s_waitcnt lgkmcnt(1)
  v_pk_add_f32 v[24:25], v[24:25], v[40:41]
  v_pk_add_f32 v[26:27], v[26:27], v[42:43]
  s_waitcnt lgkmcnt(0)
  v_pk_add_f32 v[28:29], v[28:29], v[44:45]
  v_pk_add_f32 v[30:31], v[30:31], v[46:47]
  v_pk_add_f32 v[16:17], v[16:17], v[24:25]
  v_pk_add_f32 v[18:19], v[18:19], v[26:27]
  v_pk_add_f32 v[20:21], v[20:21], v[28:29]
  v_pk_add_f32 v[22:23], v[22:23], v[30:31]
  v_pk_add_f32 v[16:17], v[16:17], v[20:21]
  v_pk_add_f32 v[18:19], v[18:19], v[22:23]
  v_cvt_pk_bf16_f32 v16, v16, v17
  v_cvt_pk_bf16_f32 v17, v18, v19
  v_cndmask_b32_e64 v20, v16, 0, vcc
  v_cndmask_b32_e64 v21, v17, 0, vcc
  buffer_store_dwordx2 v[20:21], v5, s[16:19], s58 offen sc1
  s_nop 1
L_AH:
  v_and_b32 v2, 15, v0
  v_lshrrev_b32 v7, 4, v0
  s_mul_i32 s64, s44, 14
  v_add_u32 v7, s64, v7
  s_mul_i32 s64, s45, 28672
  s_add_u32 s64, s64, 32768
  v_lshl_add_u32 v2, v2, 4, s64
  v_mov_b32 v10, 90112
  v_cmp_lt_u32 vcc, 47, v0
  v_add_u32 v3, 0, v7
  v_lshrrev_b32 v4, 3, v3
  v_lshl_add_u32 v160, v4, 10, v2
  v_and_b32 v4, 3, v3
  v_lshl_add_u32 v160, v4, 8, v160
  v_bfe_u32 v4, v3, 2, 1
  v_lshl_add_u32 v160, v4, 3, v160
  v_add_u32 v3, 4, v7
  v_lshrrev_b32 v4, 3, v3
  v_lshl_add_u32 v161, v4, 10, v2
  v_and_b32 v4, 3, v3
  v_lshl_add_u32 v161, v4, 8, v161
  v_bfe_u32 v4, v3, 2, 1
  v_lshl_add_u32 v161, v4, 3, v161
  v_cndmask_b32 v161, v161, v10, vcc
  v_add_u32 v3, 7, v7
  v_lshrrev_b32 v4, 3, v3
  v_lshl_add_u32 v162, v4, 10, v2
  v_and_b32 v4, 3, v3
  v_lshl_add_u32 v162, v4, 8, v162
  v_bfe_u32 v4, v3, 2, 1
  v_lshl_add_u32 v162, v4, 3, v162
  v_add_u32 v3, 11, v7
  v_lshrrev_b32 v4, 3, v3
  v_lshl_add_u32 v163, v4, 10, v2
  v_and_b32 v4, 3, v3
  v_lshl_add_u32 v163, v4, 8, v163
  v_bfe_u32 v4, v3, 2, 1
  v_lshl_add_u32 v163, v4, 3, v163
  v_cndmask_b32 v163, v163, v10, vcc
  v_add_u32 v3, 56, v7
  v_lshrrev_b32 v4, 3, v3
  v_lshl_add_u32 v164, v4, 10, v2
  v_and_b32 v4, 3, v3
  v_lshl_add_u32 v164, v4, 8, v164
  v_bfe_u32 v4, v3, 2, 1
  v_min_u32 v8, 6, v0
  v_lshlrev_b32 v8, 10, v8
  s_lshl_b32 s64, s41, 13
  s_add_u32 s64, s64, 524288
  buffer_load_dword v9, v8, s[16:19], s64 offen offset:12 sc1
  s_add_u32 s64, s55, 0
  buffer_load_dwordx4 v[64:67], v5, s[16:19], s64 offen offset:0 sc1
  v_lshl_add_u32 v164, v4, 3, v164
  v_add_u32 v3, 60, v7
  buffer_load_dwordx4 v[68:71], v5, s[16:19], s64 offen offset:1024 sc1
  v_lshrrev_b32 v4, 3, v3
  v_lshl_add_u32 v165, v4, 10, v2
  buffer_load_dwordx4 v[72:75], v5, s[16:19], s64 offen offset:2048 sc1
  v_and_b32 v4, 3, v3
  v_lshl_add_u32 v165, v4, 8, v165
  s_add_u32 s64, s55, 3072
  buffer_load_dwordx4 v[76:79], v5, s[16:19], s64 offen offset:0 sc1
  v_bfe_u32 v4, v3, 2, 1
  v_lshl_add_u32 v165, v4, 3, v165
  buffer_load_dwordx4 v[80:83], v5, s[16:19], s64 offen offset:1024 sc1
  v_cndmask_b32 v165, v165, v10, vcc
  v_add_u32 v3, 63, v7
  buffer_load_dwordx4 v[84:87], v5, s[16:19], s64 offen offset:2048 sc1
  v_lshrrev_b32 v4, 3, v3
  v_lshl_add_u32 v166, v4, 10, v2
  s_add_u32 s64, s55, 24576
  buffer_load_dwordx4 v[88:91], v5, s[16:19], s64 offen offset:0 sc1
  v_and_b32 v4, 3, v3
  v_lshl_add_u32 v166, v4, 8, v166
  buffer_load_dwordx4 v[92:95], v5, s[16:19], s64 offen offset:1024 sc1
  v_bfe_u32 v4, v3, 2, 1
  v_lshl_add_u32 v166, v4, 3, v166
  buffer_load_dwordx4 v[96:99], v5, s[16:19], s64 offen offset:2048 sc1
  v_add_u32 v3, 67, v7
  v_lshrrev_b32 v4, 3, v3
  s_add_u32 s64, s55, 27648
  buffer_load_dwordx4 v[100:103], v5, s[16:19], s64 offen offset:0 sc1
  v_lshl_add_u32 v167, v4, 10, v2
  v_and_b32 v4, 3, v3
  buffer_load_dwordx4 v[104:107], v5, s[16:19], s64 offen offset:1024 sc1
  v_lshl_add_u32 v167, v4, 8, v167
  v_bfe_u32 v4, v3, 2, 1
  buffer_load_dwordx4 v[108:111], v5, s[16:19], s64 offen offset:2048 sc1
  v_lshl_add_u32 v167, v4, 3, v167
  v_cndmask_b32 v167, v167, v10, vcc
  s_branch L_AI
L_AG:
  s_add_u32 s64, s55, 0
  buffer_load_dwordx4 v[64:67], v5, s[16:19], s64 offen offset:0 sc1
  buffer_load_dwordx4 v[68:71], v5, s[16:19], s64 offen offset:1024 sc1
  buffer_load_dwordx4 v[72:75], v5, s[16:19], s64 offen offset:2048 sc1
  s_add_u32 s64, s55, 3072
  buffer_load_dwordx4 v[76:79], v5, s[16:19], s64 offen offset:0 sc1
  buffer_load_dwordx4 v[80:83], v5, s[16:19], s64 offen offset:1024 sc1
  buffer_load_dwordx4 v[84:87], v5, s[16:19], s64 offen offset:2048 sc1
  s_add_u32 s64, s55, 24576
  buffer_load_dwordx4 v[88:91], v5, s[16:19], s64 offen offset:0 sc1
  buffer_load_dwordx4 v[92:95], v5, s[16:19], s64 offen offset:1024 sc1
  buffer_load_dwordx4 v[96:99], v5, s[16:19], s64 offen offset:2048 sc1
  s_add_u32 s64, s55, 27648
  buffer_load_dwordx4 v[100:103], v5, s[16:19], s64 offen offset:0 sc1
  buffer_load_dwordx4 v[104:107], v5, s[16:19], s64 offen offset:1024 sc1
  buffer_load_dwordx4 v[108:111], v5, s[16:19], s64 offen offset:2048 sc1
L_AI:
  s_nop 1
  s_waitcnt vmcnt(9)
  v_mfma_f32_16x16x32_bf16 v[24:27], v[72:75], v[224:227], 0
  v_mfma_f32_16x16x32_bf16 v[16:19], v[64:67], v[224:227], 0
  v_mfma_f32_16x16x32_bf16 v[20:23], v[68:71], v[224:227], 0
  v_mfma_f32_16x16x32_bf16 v[36:39], v[72:75], v[228:231], 0
  v_mfma_f32_16x16x32_bf16 v[28:31], v[64:67], v[228:231], 0
  v_mfma_f32_16x16x32_bf16 v[32:35], v[68:71], v[228:231], 0
  v_max_u32 v14, v65, v67
  v_max3_u32 v14, v14, v69, v71
  v_max3_u32 v14, v14, v73, v75
  s_waitcnt vmcnt(6)
  v_mfma_f32_16x16x32_bf16 v[48:51], v[84:87], v[232:235], 0
  v_mfma_f32_16x16x32_bf16 v[40:43], v[76:79], v[232:235], 0
  v_mfma_f32_16x16x32_bf16 v[44:47], v[80:83], v[232:235], 0
  v_mfma_f32_16x16x32_bf16 v[60:63], v[84:87], v[236:239], 0
  v_mfma_f32_16x16x32_bf16 v[52:55], v[76:79], v[236:239], 0
  v_mfma_f32_16x16x32_bf16 v[56:59], v[80:83], v[236:239], 0
  v_max3_u32 v14, v14, v77, v79
  v_max3_u32 v14, v14, v81, v83
  v_max3_u32 v14, v14, v85, v87
  s_waitcnt vmcnt(3)
  v_mfma_f32_16x16x32_bf16 v[120:123], v[96:99], v[176:179], 0
  v_mfma_f32_16x16x32_bf16 v[112:115], v[88:91], v[176:179], 0
  v_mfma_f32_16x16x32_bf16 v[116:119], v[92:95], v[176:179], 0
  v_mfma_f32_16x16x32_bf16 v[132:135], v[96:99], v[180:183], 0
  v_mfma_f32_16x16x32_bf16 v[124:127], v[88:91], v[180:183], 0
  v_mfma_f32_16x16x32_bf16 v[128:131], v[92:95], v[180:183], 0
  v_max3_u32 v14, v14, v89, v91
  v_max3_u32 v14, v14, v93, v95
  v_max3_u32 v14, v14, v97, v99
  s_waitcnt vmcnt(0)
  v_mfma_f32_16x16x32_bf16 v[144:147], v[108:111], v[184:187], 0
  v_mfma_f32_16x16x32_bf16 v[136:139], v[100:103], v[184:187], 0
  v_mfma_f32_16x16x32_bf16 v[140:143], v[104:107], v[184:187], 0
  v_mfma_f32_16x16x32_bf16 v[156:159], v[108:111], v[188:191], 0
  v_mfma_f32_16x16x32_bf16 v[148:151], v[100:103], v[188:191], 0
  v_mfma_f32_16x16x32_bf16 v[152:155], v[104:107], v[188:191], 0
  v_max3_u32 v14, v14, v101, v103
  v_max3_u32 v14, v14, v105, v107
  v_max3_u32 v14, v14, v109, v111
  v_cmp_eq_u32 vcc, -1, v14
  s_cbranch_vccz L_AO
  s_sleep 2
  s_sub_u32 s62, s62, 1
  s_cbranch_scc0 L_AG
L_AO:
  v_add_f32 v24, 0x358637bd, v24
  v_add_f32 v36, 0x358637bd, v36
  v_rcp_f32 v24, v24
  v_rcp_f32 v36, v36
  v_pk_mul_f32 v[16:17], v[16:17], v[24:25] op_sel_hi:[1,0]
  v_pk_mul_f32 v[18:19], v[18:19], v[24:25] op_sel_hi:[1,0]
  v_pk_mul_f32 v[20:21], v[20:21], v[24:25] op_sel_hi:[1,0]
  v_pk_mul_f32 v[22:23], v[22:23], v[24:25] op_sel_hi:[1,0]
  v_cvt_pk_bf16_f32 v16, v16, v17
  v_cvt_pk_bf16_f32 v17, v18, v19
  ds_write_b64 v160, v[16:17] offset:0
  v_cvt_pk_bf16_f32 v20, v20, v21
  v_cvt_pk_bf16_f32 v21, v22, v23
  ds_write_b64 v161, v[20:21] offset:0
  v_pk_mul_f32 v[28:29], v[28:29], v[36:37] op_sel_hi:[1,0]
  v_pk_mul_f32 v[30:31], v[30:31], v[36:37] op_sel_hi:[1,0]
  v_pk_mul_f32 v[32:33], v[32:33], v[36:37] op_sel_hi:[1,0]
  v_pk_mul_f32 v[34:35], v[34:35], v[36:37] op_sel_hi:[1,0]
  v_cvt_pk_bf16_f32 v28, v28, v29
  v_cvt_pk_bf16_f32 v29, v30, v31
  ds_write_b64 v160, v[28:29] offset:14336
  v_cvt_pk_bf16_f32 v32, v32, v33
  v_cvt_pk_bf16_f32 v33, v34, v35
  ds_write_b64 v161, v[32:33] offset:14336
  v_add_f32 v48, 0x358637bd, v48
  v_add_f32 v60, 0x358637bd, v60
  v_rcp_f32 v48, v48
  v_rcp_f32 v60, v60
  v_pk_mul_f32 v[40:41], v[40:41], v[48:49] op_sel_hi:[1,0]
  v_pk_mul_f32 v[42:43], v[42:43], v[48:49] op_sel_hi:[1,0]
  v_pk_mul_f32 v[44:45], v[44:45], v[48:49] op_sel_hi:[1,0]
  v_pk_mul_f32 v[46:47], v[46:47], v[48:49] op_sel_hi:[1,0]
  v_cvt_pk_bf16_f32 v40, v40, v41
  v_cvt_pk_bf16_f32 v41, v42, v43
  ds_write_b64 v162, v[40:41] offset:0
  v_cvt_pk_bf16_f32 v44, v44, v45
  v_cvt_pk_bf16_f32 v45, v46, v47
  ds_write_b64 v163, v[44:45] offset:0
  v_pk_mul_f32 v[52:53], v[52:53], v[60:61] op_sel_hi:[1,0]
  v_pk_mul_f32 v[54:55], v[54:55], v[60:61] op_sel_hi:[1,0]
  v_pk_mul_f32 v[56:57], v[56:57], v[60:61] op_sel_hi:[1,0]
  v_pk_mul_f32 v[58:59], v[58:59], v[60:61] op_sel_hi:[1,0]
  v_cvt_pk_bf16_f32 v52, v52, v53
  v_cvt_pk_bf16_f32 v53, v54, v55
  ds_write_b64 v162, v[52:53] offset:14336
  v_cvt_pk_bf16_f32 v56, v56, v57
  v_cvt_pk_bf16_f32 v57, v58, v59
  ds_write_b64 v163, v[56:57] offset:14336
  v_add_f32 v120, 0x358637bd, v120
  v_add_f32 v132, 0x358637bd, v132
  v_rcp_f32 v120, v120
  v_rcp_f32 v132, v132
  v_pk_mul_f32 v[112:113], v[112:113], v[120:121] op_sel_hi:[1,0]
  v_pk_mul_f32 v[114:115], v[114:115], v[120:121] op_sel_hi:[1,0]
  v_pk_mul_f32 v[116:117], v[116:117], v[120:121] op_sel_hi:[1,0]
  v_pk_mul_f32 v[118:119], v[118:119], v[120:121] op_sel_hi:[1,0]
  v_cvt_pk_bf16_f32 v112, v112, v113
  v_cvt_pk_bf16_f32 v113, v114, v115
  ds_write_b64 v164, v[112:113] offset:0
  v_cvt_pk_bf16_f32 v116, v116, v117
  v_cvt_pk_bf16_f32 v117, v118, v119
  ds_write_b64 v165, v[116:117] offset:0
  v_pk_mul_f32 v[124:125], v[124:125], v[132:133] op_sel_hi:[1,0]
  v_pk_mul_f32 v[126:127], v[126:127], v[132:133] op_sel_hi:[1,0]
  v_pk_mul_f32 v[128:129], v[128:129], v[132:133] op_sel_hi:[1,0]
  v_pk_mul_f32 v[130:131], v[130:131], v[132:133] op_sel_hi:[1,0]
  v_cvt_pk_bf16_f32 v124, v124, v125
  v_cvt_pk_bf16_f32 v125, v126, v127
  ds_write_b64 v164, v[124:125] offset:14336
  v_cvt_pk_bf16_f32 v128, v128, v129
  v_cvt_pk_bf16_f32 v129, v130, v131
  ds_write_b64 v165, v[128:129] offset:14336
  v_add_f32 v144, 0x358637bd, v144
  v_add_f32 v156, 0x358637bd, v156
  v_rcp_f32 v144, v144
  v_rcp_f32 v156, v156
  v_pk_mul_f32 v[136:137], v[136:137], v[144:145] op_sel_hi:[1,0]
  v_pk_mul_f32 v[138:139], v[138:139], v[144:145] op_sel_hi:[1,0]
  v_pk_mul_f32 v[140:141], v[140:141], v[144:145] op_sel_hi:[1,0]
  v_pk_mul_f32 v[142:143], v[142:143], v[144:145] op_sel_hi:[1,0]
  v_cvt_pk_bf16_f32 v136, v136, v137
  v_cvt_pk_bf16_f32 v137, v138, v139
  ds_write_b64 v166, v[136:137] offset:0
  v_cvt_pk_bf16_f32 v140, v140, v141
  v_cvt_pk_bf16_f32 v141, v142, v143
  ds_write_b64 v167, v[140:141] offset:0
  v_pk_mul_f32 v[148:149], v[148:149], v[156:157] op_sel_hi:[1,0]
  v_pk_mul_f32 v[150:151], v[150:151], v[156:157] op_sel_hi:[1,0]
  v_pk_mul_f32 v[152:153], v[152:153], v[156:157] op_sel_hi:[1,0]
  v_pk_mul_f32 v[154:155], v[154:155], v[156:157] op_sel_hi:[1,0]
  v_cvt_pk_bf16_f32 v148, v148, v149
  v_cvt_pk_bf16_f32 v149, v150, v151
  ds_write_b64 v166, v[148:149] offset:14336
  v_cvt_pk_bf16_f32 v152, v152, v153
  v_cvt_pk_bf16_f32 v153, v154, v155
  ds_write_b64 v167, v[152:153] offset:14336
  s_mul_i32 s64, s40, 7168
  s_add_u32 s64, s64, 32768
  v_add_u32 v2, s64, v5
  s_add_u32 s68, s56, 4096
  s_waitcnt lgkmcnt(0)
  s_barrier
  ds_read_b128 v[64:67], v2 offset:0
  ds_read_b128 v[68:71], v2 offset:1024
  ds_read_b128 v[72:75], v2 offset:2048
  ds_read_b128 v[76:79], v2 offset:3072
  ds_read_b128 v[80:83], v2 offset:4096
  ds_read_b128 v[84:87], v2 offset:5120
  ds_read_b128 v[88:91], v2 offset:6144
  v_cmp_ne_u32 vcc, s100, v9
  s_nop 1
  s_cbranch_vccnz L_OW
  s_waitcnt lgkmcnt(6)
  buffer_store_dwordx4 v[64:67], v5, s[16:19], s56 offen offset:0
  s_waitcnt lgkmcnt(5)
  buffer_store_dwordx4 v[68:71], v5, s[16:19], s56 offen offset:1024
  s_waitcnt lgkmcnt(4)
  buffer_store_dwordx4 v[72:75], v5, s[16:19], s56 offen offset:2048
  s_waitcnt lgkmcnt(3)
  buffer_store_dwordx4 v[76:79], v5, s[16:19], s56 offen offset:3072
  s_waitcnt lgkmcnt(2)
  buffer_store_dwordx4 v[80:83], v5, s[16:19], s68 offen offset:0
  s_waitcnt lgkmcnt(1)
  buffer_store_dwordx4 v[84:87], v5, s[16:19], s68 offen offset:1024
  s_waitcnt lgkmcnt(0)
  buffer_store_dwordx4 v[88:91], v5, s[16:19], s68 offen offset:2048
  s_branch L_OB
L_OW:
  s_waitcnt lgkmcnt(6)
  buffer_store_dwordx4 v[64:67], v5, s[16:19], s56 offen offset:0 sc1
  s_waitcnt lgkmcnt(5)
  buffer_store_dwordx4 v[68:71], v5, s[16:19], s56 offen offset:1024 sc1
  s_waitcnt lgkmcnt(4)
  buffer_store_dwordx4 v[72:75], v5, s[16:19], s56 offen offset:2048 sc1
  s_waitcnt lgkmcnt(3)
  buffer_store_dwordx4 v[76:79], v5, s[16:19], s56 offen offset:3072 sc1
  s_waitcnt lgkmcnt(2)
  buffer_store_dwordx4 v[80:83], v5, s[16:19], s68 offen offset:0 sc1
  s_waitcnt lgkmcnt(1)
  buffer_store_dwordx4 v[84:87], v5, s[16:19], s68 offen offset:1024 sc1
  s_waitcnt lgkmcnt(0)
  buffer_store_dwordx4 v[88:91], v5, s[16:19], s68 offen offset:2048 sc1
L_OB:
  s_or_b32 s64, s40, s41
  s_cmp_lg_u32 s64, 0
  s_cbranch_scc1 L_END
  s_mov_b32 s57, 262144
  s_mov_b64 exec, 1
  v_mov_b32 v14, s43
  buffer_store_dword v14, off, s[16:19], s57 sc1
  s_mov_b64 exec, -1
L_END:
L_EXIT:
  s_endpgm
.section .rodata,"a"
.p2align 6
.amdhsa_kernel parallel_sum__linear_attn_block__mixer_gmlp__prompt_kernel
  .amdhsa_next_free_vgpr 256
  .amdhsa_next_free_sgpr 102
  .amdhsa_accum_offset 256
  .amdhsa_group_segment_fixed_size 0
  .amdhsa_kernarg_size 88
  .amdhsa_user_sgpr_count 2
  .amdhsa_user_sgpr_kernarg_segment_ptr 1
  .amdhsa_system_sgpr_workgroup_id_x 1
.end_amdhsa_kernel
```
